```python
import torch

def _softmax(x, axis=-1):
    return torch.softmax(x, dim=axis)
def _gelu(x):
    return torch.nn.functional.gelu(x, approximate="tanh")
def _silu(x):
    return torch.nn.functional.silu(x)
def _sigmoid(x):
    return torch.sigmoid(x)
def _layernorm(x, axis=-1, eps=1e-5):
    m = x.mean(dim=axis, keepdim=True)
    v = x.var(dim=axis, keepdim=True, unbiased=False)
    return (x - m) / torch.sqrt(v + eps)
def _scatter_add(tgt, idx, src, axis=0):
    return tgt.clone().index_add_(axis, idx, src)
def _segment_sum(src, seg, n):
    out = torch.zeros((n,) + src.shape[1:], dtype=src.dtype)
    return out.index_add_(0, seg, src)
def _pad(x, pw):
    flat = tuple(v for pair in reversed(pw) for v in pair)
    return torch.nn.functional.pad(x, flat)

kernel_name = 'standalone__gqa_block_cached__decode'

def setup_inputs():

    _w = (lambda a: (lambda t: t.to(torch.bfloat16) if t.is_floating_point() else t)(torch.as_tensor(a)))
    B, Sq, D = 1, 1, 640
    Hq, Hkv, Sk, Dh = 32, 32, 32768, 192
    assert Hq % Hkv == 0, (Hq, Hkv)
    return {
        "x": _w((lambda *s: torch.randn(*s, dtype=torch.bfloat16) * 0.8)(B, Sq, D)),
        "k_cache": _w((lambda *s: torch.randn(*s, dtype=torch.bfloat16) * 0.8)(B, Hkv, Sk, Dh)),
        "v_cache": _w((lambda *s: torch.randn(*s, dtype=torch.bfloat16) * 0.05)(B, Hkv, Sk, Dh)),
        "wq": _w((lambda *s: torch.randn(*s, dtype=torch.bfloat16) * 0.8)(D, Hq * Dh) * (D ** -0.5)),
        "wo": _w((lambda *s: torch.randn(*s, dtype=torch.bfloat16) * 0.05)(Hq * Dh, D) * ((Hq * Dh) ** -0.5)),
    }

def reference(x, k_cache, v_cache, wq, wo):
    B, Sq, D = x.shape
    Hq, Dh = 32, 192
    Hkv = k_cache.shape[1]
    rep = Hq // Hkv
    q = (lambda x, *d: x.permute(*d))((x @ wq).reshape(B, Sq, Hq, Dh), 0, 2, 1, 3)
    k = (lambda x, n, axis: torch.repeat_interleave(x, n, dim=axis))(k_cache, rep, axis=1)
    v = (lambda x, n, axis: torch.repeat_interleave(x, n, dim=axis))(v_cache, rep, axis=1)
    scores = torch.einsum("bhqd,bhkd->bhqk", q, k) * (Dh ** -0.5)
    p = _softmax(scores, axis=-1)
    o = torch.einsum("bhqk,bhkd->bhqd", p, v)
    return (lambda x, *d: x.permute(*d))(o, 0, 2, 1, 3).reshape(B, Sq, Hq * Dh) @ wo
```

```asm
; @launch grid=(256,1,1) block=(512,1,1) lds=28160
.amdgcn_target "amdgcn-amd-amdhsa--gfx950"
.text
.globl standalone__gqa_block_cached__decode_kernel
.p2align 8
.type standalone__gqa_block_cached__decode_kernel,@function
standalone__gqa_block_cached__decode_kernel:
    s_cmp_ge_u32 s2, 256
    s_cbranch_scc1 L_end
    s_load_dwordx16 s[36:51], s[0:1], 0
    v_lshrrev_b32 v2, 6, v0
    v_and_b32 v240, 63, v0
    v_readfirstlane_b32 s3, v2
    v_lshrrev_b32 v242, 3, v240
    v_and_b32 v243, 7, v240
    v_lshlrev_b32 v243, 4, v243
    v_mul_u32_u24 v5, 384, v242
    v_add_u32 v1, v5, v243
    s_lshr_b32 s4, s2, 3
    s_and_b32 s5, s2, 7
    s_mul_i32 s31, s4, 12582912
    s_mov_b32 s33, 0xffff0000
    s_mov_b32 s34, 0x3dd53b95
    v_mov_b32 v241, 0
    s_cmp_eq_u32 s3, 0
    s_waitcnt lgkmcnt(0)
    s_cbranch_scc1 L_coord
    s_mov_b32 s8, s38
    s_mov_b32 s9, s39
    s_mov_b32 s10, 0x18000000
    s_mov_b32 s11, 0x20000
    s_mov_b32 s12, s40
    s_mov_b32 s13, s41
    s_mov_b32 s14, 0x18000000
    s_mov_b32 s15, 0x20000
    s_mul_i32 s6, s5, 7
    s_add_u32 s6, s6, s3
    s_mul_i32 s7, s4, 11
    s_add_u32 s6, s6, s7
    s_sub_u32 s6, s6, 1
    s_and_b32 s6, s6, 511
    s_mul_i32 s6, s6, 24576
    s_add_u32 s28, s6, s31
    s_cmp_lt_u32 s3, 4
    s_cbranch_scc1 L_one
    s_mov_b32 s7, 0
    s_barrier
    buffer_load_dwordx4 v[48:51], v1, s[8:11], s28 offen offset:0 nt
    buffer_load_dwordx4 v[52:55], v1, s[8:11], s28 offen offset:128 nt
    buffer_load_dwordx4 v[56:59], v1, s[8:11], s28 offen offset:256 nt
    buffer_load_dwordx4 v[60:63], v1, s[12:15], s28 offen offset:0 nt
    buffer_load_dwordx4 v[64:67], v1, s[12:15], s28 offen offset:128 nt
    buffer_load_dwordx4 v[68:71], v1, s[12:15], s28 offen offset:256 nt
    s_add_u32 s28, s28, 3072
    s_cmp_lg_u32 s7, 0
    s_cbranch_scc1 L_ups2
    ds_read_b32 v5, v241 offset:384
    s_waitcnt vmcnt(3) lgkmcnt(0)
    v_readfirstlane_b32 s7, v5
L_ups2:
    buffer_load_dwordx4 v[72:75], v1, s[8:11], s28 offen offset:0 nt
    buffer_load_dwordx4 v[76:79], v1, s[8:11], s28 offen offset:128 nt
    buffer_load_dwordx4 v[80:83], v1, s[8:11], s28 offen offset:256 nt
    s_cmp_lg_u32 s7, 0
    s_cbranch_scc1 L_ups3
    ds_read_b32 v5, v241 offset:384
    s_waitcnt vmcnt(3) lgkmcnt(0)
    v_readfirstlane_b32 s7, v5
L_ups3:
    buffer_load_dwordx4 v[84:87], v1, s[12:15], s28 offen offset:0 nt
    buffer_load_dwordx4 v[88:91], v1, s[12:15], s28 offen offset:128 nt
    buffer_load_dwordx4 v[92:95], v1, s[12:15], s28 offen offset:256 nt
    s_add_u32 s28, s28, 3072
    s_cmp_lg_u32 s7, 0
    s_cbranch_scc1 L_ups4
    ds_read_b32 v5, v241 offset:384
    s_waitcnt vmcnt(3) lgkmcnt(0)
    v_readfirstlane_b32 s7, v5
L_ups4:
    buffer_load_dwordx4 v[96:99], v1, s[8:11], s28 offen offset:0 nt
    buffer_load_dwordx4 v[100:103], v1, s[8:11], s28 offen offset:128 nt
    buffer_load_dwordx4 v[104:107], v1, s[8:11], s28 offen offset:256 nt
    s_cmp_lg_u32 s7, 0
    s_cbranch_scc1 L_ups5
    ds_read_b32 v5, v241 offset:384
    s_waitcnt vmcnt(3) lgkmcnt(0)
    v_readfirstlane_b32 s7, v5
L_ups5:
    buffer_load_dwordx4 v[108:111], v1, s[12:15], s28 offen offset:0 nt
    buffer_load_dwordx4 v[112:115], v1, s[12:15], s28 offen offset:128 nt
    buffer_load_dwordx4 v[116:119], v1, s[12:15], s28 offen offset:256 nt
    s_add_u32 s28, s28, 3072
    s_cmp_lg_u32 s7, 0
    s_cbranch_scc1 L_ups6
    ds_read_b32 v5, v241 offset:384
    s_waitcnt vmcnt(3) lgkmcnt(0)
    v_readfirstlane_b32 s7, v5
L_ups6:
    buffer_load_dwordx4 v[120:123], v1, s[8:11], s28 offen offset:0 nt
    buffer_load_dwordx4 v[124:127], v1, s[8:11], s28 offen offset:128 nt
    buffer_load_dwordx4 v[128:131], v1, s[8:11], s28 offen offset:256 nt
    s_cmp_lg_u32 s7, 0
    s_cbranch_scc1 L_ups7
    ds_read_b32 v5, v241 offset:384
    s_waitcnt vmcnt(3) lgkmcnt(0)
    v_readfirstlane_b32 s7, v5
L_ups7:
    buffer_load_dwordx4 v[132:135], v1, s[12:15], s28 offen offset:0 nt
    buffer_load_dwordx4 v[136:139], v1, s[12:15], s28 offen offset:128 nt
    buffer_load_dwordx4 v[140:143], v1, s[12:15], s28 offen offset:256 nt
    s_add_u32 s28, s28, 3072
    s_cmp_lg_u32 s7, 0
    s_cbranch_scc1 L_ups8
    ds_read_b32 v5, v241 offset:384
    s_waitcnt vmcnt(3) lgkmcnt(0)
    v_readfirstlane_b32 s7, v5
L_ups8:
    buffer_load_dwordx4 v[144:147], v1, s[8:11], s28 offen offset:0 nt
    buffer_load_dwordx4 v[148:151], v1, s[8:11], s28 offen offset:128 nt
    buffer_load_dwordx4 v[152:155], v1, s[8:11], s28 offen offset:256 nt
    s_cmp_lg_u32 s7, 0
    s_cbranch_scc1 L_ups9
    ds_read_b32 v5, v241 offset:384
    s_waitcnt vmcnt(3) lgkmcnt(0)
    v_readfirstlane_b32 s7, v5
L_ups9:
    buffer_load_dwordx4 v[156:159], v1, s[12:15], s28 offen offset:0 nt
    buffer_load_dwordx4 v[160:163], v1, s[12:15], s28 offen offset:128 nt
    buffer_load_dwordx4 v[164:167], v1, s[12:15], s28 offen offset:256 nt
    s_add_u32 s28, s28, 3072
    s_cmp_lg_u32 s7, 0
    s_cbranch_scc1 L_ups10
    ds_read_b32 v5, v241 offset:384
    s_waitcnt vmcnt(3) lgkmcnt(0)
    v_readfirstlane_b32 s7, v5
L_ups10:
    buffer_load_dwordx4 v[168:171], v1, s[8:11], s28 offen offset:0 nt
    buffer_load_dwordx4 v[172:175], v1, s[8:11], s28 offen offset:128 nt
    buffer_load_dwordx4 v[176:179], v1, s[8:11], s28 offen offset:256 nt
    s_cmp_lg_u32 s7, 0
    s_cbranch_scc1 L_ups11
    ds_read_b32 v5, v241 offset:384
    s_waitcnt vmcnt(3) lgkmcnt(0)
    v_readfirstlane_b32 s7, v5
L_ups11:
    buffer_load_dwordx4 v[180:183], v1, s[12:15], s28 offen offset:0 nt
    buffer_load_dwordx4 v[184:187], v1, s[12:15], s28 offen offset:128 nt
    buffer_load_dwordx4 v[188:191], v1, s[12:15], s28 offen offset:256 nt
    s_add_u32 s28, s28, 3072
    s_cmp_lg_u32 s7, 0
    s_cbranch_scc1 L_ups12
    ds_read_b32 v5, v241 offset:384
    s_waitcnt vmcnt(3) lgkmcnt(0)
    v_readfirstlane_b32 s7, v5
L_ups12:
    buffer_load_dwordx4 v[192:195], v1, s[8:11], s28 offen offset:0 nt
    buffer_load_dwordx4 v[196:199], v1, s[8:11], s28 offen offset:128 nt
    buffer_load_dwordx4 v[200:203], v1, s[8:11], s28 offen offset:256 nt
    s_cmp_lg_u32 s7, 0
    s_cbranch_scc1 L_ups13
    ds_read_b32 v5, v241 offset:384
    s_waitcnt vmcnt(3) lgkmcnt(0)
    v_readfirstlane_b32 s7, v5
L_ups13:
    buffer_load_dwordx4 v[204:207], v1, s[12:15], s28 offen offset:0 nt
    buffer_load_dwordx4 v[208:211], v1, s[12:15], s28 offen offset:128 nt
    buffer_load_dwordx4 v[212:215], v1, s[12:15], s28 offen offset:256 nt
    s_add_u32 s28, s28, 3072
    s_cmp_lg_u32 s7, 0
    s_cbranch_scc1 L_ups14
    ds_read_b32 v5, v241 offset:384
    s_waitcnt vmcnt(3) lgkmcnt(0)
    v_readfirstlane_b32 s7, v5
L_ups14:
    buffer_load_dwordx4 v[216:219], v1, s[8:11], s28 offen offset:0 nt
    buffer_load_dwordx4 v[220:223], v1, s[8:11], s28 offen offset:128 nt
    buffer_load_dwordx4 v[224:227], v1, s[8:11], s28 offen offset:256 nt
    s_cmp_lg_u32 s7, 0
    s_cbranch_scc1 L_ups15
    ds_read_b32 v5, v241 offset:384
    s_waitcnt vmcnt(3) lgkmcnt(0)
    v_readfirstlane_b32 s7, v5
L_ups15:
    buffer_load_dwordx4 v[228:231], v1, s[12:15], s28 offen offset:0 nt
    buffer_load_dwordx4 v[232:235], v1, s[12:15], s28 offen offset:128 nt
    buffer_load_dwordx4 v[236:239], v1, s[12:15], s28 offen offset:256 nt
    s_mov_b32 s29, 0
    s_branch L_pre
L_one:
    s_mov_b32 s7, 0
    s_barrier
    buffer_load_dwordx4 v[120:123], v1, s[8:11], s28 offen offset:0 nt
    buffer_load_dwordx4 v[124:127], v1, s[8:11], s28 offen offset:128 nt
    buffer_load_dwordx4 v[128:131], v1, s[8:11], s28 offen offset:256 nt
    buffer_load_dwordx4 v[132:135], v1, s[12:15], s28 offen offset:0 nt
    buffer_load_dwordx4 v[136:139], v1, s[12:15], s28 offen offset:128 nt
    buffer_load_dwordx4 v[140:143], v1, s[12:15], s28 offen offset:256 nt
    s_add_u32 s28, s28, 3072
    s_cmp_lg_u32 s7, 0
    s_cbranch_scc1 L_upo2
    ds_read_b32 v5, v241 offset:384
    s_waitcnt vmcnt(3) lgkmcnt(0)
    v_readfirstlane_b32 s7, v5
L_upo2:
    buffer_load_dwordx4 v[144:147], v1, s[8:11], s28 offen offset:0 nt
    buffer_load_dwordx4 v[148:151], v1, s[8:11], s28 offen offset:128 nt
    buffer_load_dwordx4 v[152:155], v1, s[8:11], s28 offen offset:256 nt
    s_cmp_lg_u32 s7, 0
    s_cbranch_scc1 L_upo3
    ds_read_b32 v5, v241 offset:384
    s_waitcnt vmcnt(3) lgkmcnt(0)
    v_readfirstlane_b32 s7, v5
L_upo3:
    buffer_load_dwordx4 v[156:159], v1, s[12:15], s28 offen offset:0 nt
    buffer_load_dwordx4 v[160:163], v1, s[12:15], s28 offen offset:128 nt
    buffer_load_dwordx4 v[164:167], v1, s[12:15], s28 offen offset:256 nt
    s_add_u32 s28, s28, 3072
    s_cmp_lg_u32 s7, 0
    s_cbranch_scc1 L_upo4
    ds_read_b32 v5, v241 offset:384
    s_waitcnt vmcnt(3) lgkmcnt(0)
    v_readfirstlane_b32 s7, v5
L_upo4:
    buffer_load_dwordx4 v[168:171], v1, s[8:11], s28 offen offset:0 nt
    buffer_load_dwordx4 v[172:175], v1, s[8:11], s28 offen offset:128 nt
    buffer_load_dwordx4 v[176:179], v1, s[8:11], s28 offen offset:256 nt
    s_cmp_lg_u32 s7, 0
    s_cbranch_scc1 L_upo5
    ds_read_b32 v5, v241 offset:384
    s_waitcnt vmcnt(3) lgkmcnt(0)
    v_readfirstlane_b32 s7, v5
L_upo5:
    buffer_load_dwordx4 v[180:183], v1, s[12:15], s28 offen offset:0 nt
    buffer_load_dwordx4 v[184:187], v1, s[12:15], s28 offen offset:128 nt
    buffer_load_dwordx4 v[188:191], v1, s[12:15], s28 offen offset:256 nt
    s_add_u32 s28, s28, 3072
    s_cmp_lg_u32 s7, 0
    s_cbranch_scc1 L_upo6
    ds_read_b32 v5, v241 offset:384
    s_waitcnt vmcnt(3) lgkmcnt(0)
    v_readfirstlane_b32 s7, v5
L_upo6:
    buffer_load_dwordx4 v[192:195], v1, s[8:11], s28 offen offset:0 nt
    buffer_load_dwordx4 v[196:199], v1, s[8:11], s28 offen offset:128 nt
    buffer_load_dwordx4 v[200:203], v1, s[8:11], s28 offen offset:256 nt
    s_cmp_lg_u32 s7, 0
    s_cbranch_scc1 L_upo7
    ds_read_b32 v5, v241 offset:384
    s_waitcnt vmcnt(3) lgkmcnt(0)
    v_readfirstlane_b32 s7, v5
L_upo7:
    buffer_load_dwordx4 v[204:207], v1, s[12:15], s28 offen offset:0 nt
    buffer_load_dwordx4 v[208:211], v1, s[12:15], s28 offen offset:128 nt
    buffer_load_dwordx4 v[212:215], v1, s[12:15], s28 offen offset:256 nt
    s_add_u32 s28, s28, 3072
    s_cmp_lg_u32 s7, 0
    s_cbranch_scc1 L_upo8
    ds_read_b32 v5, v241 offset:384
    s_waitcnt vmcnt(3) lgkmcnt(0)
    v_readfirstlane_b32 s7, v5
L_upo8:
    buffer_load_dwordx4 v[216:219], v1, s[8:11], s28 offen offset:0 nt
    buffer_load_dwordx4 v[220:223], v1, s[8:11], s28 offen offset:128 nt
    buffer_load_dwordx4 v[224:227], v1, s[8:11], s28 offen offset:256 nt
    s_cmp_lg_u32 s7, 0
    s_cbranch_scc1 L_upo9
    ds_read_b32 v5, v241 offset:384
    s_waitcnt vmcnt(3) lgkmcnt(0)
    v_readfirstlane_b32 s7, v5
L_upo9:
    buffer_load_dwordx4 v[228:231], v1, s[12:15], s28 offen offset:0 nt
    buffer_load_dwordx4 v[232:235], v1, s[12:15], s28 offen offset:128 nt
    buffer_load_dwordx4 v[236:239], v1, s[12:15], s28 offen offset:256 nt
    s_add_u32 s28, s28, 3072
    s_cmp_lg_u32 s7, 0
    s_cbranch_scc1 L_upo10
    ds_read_b32 v5, v241 offset:384
    s_waitcnt vmcnt(3) lgkmcnt(0)
    v_readfirstlane_b32 s7, v5
L_upo10:
    buffer_load_dwordx4 v[48:51], v1, s[8:11], s28 offen offset:0 nt
    buffer_load_dwordx4 v[52:55], v1, s[8:11], s28 offen offset:128 nt
    buffer_load_dwordx4 v[56:59], v1, s[8:11], s28 offen offset:256 nt
    s_cmp_lg_u32 s7, 0
    s_cbranch_scc1 L_upo11
    ds_read_b32 v5, v241 offset:384
    s_waitcnt vmcnt(3) lgkmcnt(0)
    v_readfirstlane_b32 s7, v5
L_upo11:
    buffer_load_dwordx4 v[60:63], v1, s[12:15], s28 offen offset:0 nt
    buffer_load_dwordx4 v[64:67], v1, s[12:15], s28 offen offset:128 nt
    buffer_load_dwordx4 v[68:71], v1, s[12:15], s28 offen offset:256 nt
    s_add_u32 s28, s28, 3072
    s_cmp_lg_u32 s7, 0
    s_cbranch_scc1 L_upo12
    ds_read_b32 v5, v241 offset:384
    s_waitcnt vmcnt(3) lgkmcnt(0)
    v_readfirstlane_b32 s7, v5
L_upo12:
    buffer_load_dwordx4 v[72:75], v1, s[8:11], s28 offen offset:0 nt
    buffer_load_dwordx4 v[76:79], v1, s[8:11], s28 offen offset:128 nt
    buffer_load_dwordx4 v[80:83], v1, s[8:11], s28 offen offset:256 nt
    s_cmp_lg_u32 s7, 0
    s_cbranch_scc1 L_upo13
    ds_read_b32 v5, v241 offset:384
    s_waitcnt vmcnt(3) lgkmcnt(0)
    v_readfirstlane_b32 s7, v5
L_upo13:
    buffer_load_dwordx4 v[84:87], v1, s[12:15], s28 offen offset:0 nt
    buffer_load_dwordx4 v[88:91], v1, s[12:15], s28 offen offset:128 nt
    buffer_load_dwordx4 v[92:95], v1, s[12:15], s28 offen offset:256 nt
    s_add_u32 s28, s28, 3072
    s_cmp_lg_u32 s7, 0
    s_cbranch_scc1 L_upo14
    ds_read_b32 v5, v241 offset:384
    s_waitcnt vmcnt(3) lgkmcnt(0)
    v_readfirstlane_b32 s7, v5
L_upo14:
    buffer_load_dwordx4 v[96:99], v1, s[8:11], s28 offen offset:0 nt
    buffer_load_dwordx4 v[100:103], v1, s[8:11], s28 offen offset:128 nt
    buffer_load_dwordx4 v[104:107], v1, s[8:11], s28 offen offset:256 nt
    s_cmp_lg_u32 s7, 0
    s_cbranch_scc1 L_upo15
    ds_read_b32 v5, v241 offset:384
    s_waitcnt vmcnt(3) lgkmcnt(0)
    v_readfirstlane_b32 s7, v5
L_upo15:
    buffer_load_dwordx4 v[108:111], v1, s[12:15], s28 offen offset:0 nt
    buffer_load_dwordx4 v[112:115], v1, s[12:15], s28 offen offset:128 nt
    buffer_load_dwordx4 v[116:119], v1, s[12:15], s28 offen offset:256 nt
    s_mov_b32 s29, 1
L_pre:
    s_load_dword s32, s[50:51], 0
    s_mov_b32 s16, s50
    s_mov_b32 s17, s51
    s_mov_b32 s18, 0x800000
    s_mov_b32 s19, 0x20000
    v_mov_b32 v7, 0xff800000
    v_mov_b32 v9, 0
    v_mov_b32 v8, 0
    v_mov_b32 v24, 0
    v_mov_b32 v25, 0
    v_mov_b32 v26, 0
    v_mov_b32 v27, 0
    v_mov_b32 v28, 0
    v_mov_b32 v29, 0
    v_mov_b32 v30, 0
    v_mov_b32 v31, 0
    v_mov_b32 v32, 0
    v_mov_b32 v33, 0
    v_mov_b32 v34, 0
    v_mov_b32 v35, 0
    v_mov_b32 v36, 0
    v_mov_b32 v37, 0
    v_mov_b32 v38, 0
    v_mov_b32 v39, 0
    v_mov_b32 v40, 0
    v_mov_b32 v41, 0
    v_mov_b32 v42, 0
    v_mov_b32 v43, 0
    v_mov_b32 v44, 0
    v_mov_b32 v45, 0
    v_mov_b32 v46, 0
    v_mov_b32 v47, 0
    v_mov_b32 v11, 4
    s_mov_b32 s20, 0
    s_mov_b32 s21, 0
    s_mov_b32 s22, 0
    s_mov_b32 s30, 0
    v_lshrrev_b32 v244, 4, v240
    v_lshlrev_b32 v244, 7, v244
    s_lshl_b32 s6, s3, 10
    v_add3_u32 v244, v244, v243, s6
    v_lshlrev_b32 v246, 4, v240
    v_lshrrev_b32 v245, 5, v240
    v_mul_u32_u24 v245, 3584, v245
    v_add_u32 v245, v245, v246
    s_lshl_b32 s58, s2, 11
    s_add_u32 s58, s58, 589824
L_wq:
    ds_read_b32 v5, v241 offset:384
    ds_read_b128 v[12:15], v243 offset:0
    ds_read_b128 v[16:19], v243 offset:128
    ds_read_b128 v[20:23], v243 offset:256
    s_waitcnt lgkmcnt(0)
    v_readfirstlane_b32 s6, v5
    s_cmp_lg_u32 s6, 0
    s_cbranch_scc1 L_qok
    s_sleep 1
    s_branch L_wq
L_qok:
    s_mul_i32 s32, s32, 0x9E3779B1
    s_add_u32 s32, s32, 0x7F4A7C15
    s_cmp_lt_u32 s3, 4
    s_cbranch_scc1 L_hi
L_loop:
    s_add_u32 s30, s30, 1
    s_cmp_lg_u32 s29, 0
    s_cbranch_scc1 L_void0
    s_mov_b64 exec, 1
    ds_add_rtn_u32 v10, v241, v11 offset:388
    s_waitcnt lgkmcnt(0)
L_pop0:
    ds_read_b32 v5, v10 offset:10752
    s_waitcnt lgkmcnt(0)
    v_readfirstlane_b32 s28, v5
    s_cmp_lt_i32 s28, 0
    s_cbranch_scc1 L_pop0
    s_mov_b64 exec, -1
    s_cmp_lg_u32 s28, 0x7fffffff
    s_cbranch_scc1 L_go0
    s_mov_b32 s29, 1
L_void0:
    s_cmp_eq_u32 s29, 4
    s_cbranch_scc1 L_done
    s_add_u32 s29, s29, 1
    s_mov_b32 s10, 0
    s_mov_b32 s14, 0
    s_mov_b32 s28, 0
L_go0:
    s_mov_b32 s23, s20
    s_and_b32 s25, s28, 3
    s_cselect_b32 s24, 3072, 0
    s_cselect_b32 s20, 0x7ff, 0
    s_and_b32 s20, s20, s28
    s_sub_u32 s28, s28, s20
    s_add_u32 s24, s24, s28
    s_cmp_eq_u32 s25, 2
    s_cselect_b64 s[8:9], s[40:41], s[38:39]
    s_cmp_eq_u32 s25, 1
    s_cselect_b64 s[12:13], s[38:39], s[40:41]
    s_and_b32 s25, s23, 3
    s_cbranch_scc1 L_sp0
    s_waitcnt vmcnt(15)
    v_dot2_f32_bf16 v2, v48, v12, 0
    v_dot2_f32_bf16 v3, v49, v13, 0
    v_dot2_f32_bf16 v2, v50, v14, v2
    v_dot2_f32_bf16 v3, v51, v15, v3
    v_dot2_f32_bf16 v2, v52, v16, v2
    v_dot2_f32_bf16 v3, v53, v17, v3
    v_dot2_f32_bf16 v2, v54, v18, v2
    v_dot2_f32_bf16 v3, v55, v19, v3
    v_dot2_f32_bf16 v2, v56, v20, v2
    v_dot2_f32_bf16 v3, v57, v21, v3
    v_dot2_f32_bf16 v2, v58, v22, v2
    v_dot2_f32_bf16 v3, v59, v23, v3
    buffer_load_dwordx4 v[48:51], v1, s[8:11], s28 offen offset:0 nt
    buffer_load_dwordx4 v[52:55], v1, s[8:11], s28 offen offset:128 nt
    buffer_load_dwordx4 v[56:59], v1, s[8:11], s28 offen offset:256 nt
    v_add_f32 v2, v2, v3
    s_nop 1
    v_add_f32_dpp v2, v2, v2 quad_perm:[1,0,3,2] row_mask:0xf bank_mask:0xf
    s_nop 1
    v_add_f32_dpp v2, v2, v2 quad_perm:[2,3,0,1] row_mask:0xf bank_mask:0xf
    s_nop 1
    v_add_f32_dpp v2, v2, v2 row_half_mirror row_mask:0xf bank_mask:0xf
    v_cmp_gt_f32 vcc, v2, v7
    s_cbranch_vccz L_nr1
    v_max_f32 v3, v2, v7
    s_nop 1
    v_max_f32_dpp v3, v3, v3 row_ror:8 row_mask:0xf bank_mask:0xf
    v_mov_b32 v5, v3
    s_nop 1
    v_permlane16_swap_b32 v5, v3
    v_max_f32 v3, v3, v5
    v_mov_b32 v5, v3
    s_nop 1
    v_permlane32_swap_b32 v5, v3
    v_max_f32 v3, v3, v5
    v_sub_f32 v5, v7, v3
    v_mul_f32 v5, s34, v5
    v_exp_f32 v4, v5
    v_mov_b32 v7, v3
    v_mul_f32 v8, s34, v3
    v_mul_f32 v9, v9, v4
    v_pk_mul_f32 v[24:25], v[24:25], v[4:5] op_sel_hi:[1,0]
    v_pk_mul_f32 v[26:27], v[26:27], v[4:5] op_sel_hi:[1,0]
    v_pk_mul_f32 v[28:29], v[28:29], v[4:5] op_sel_hi:[1,0]
    v_pk_mul_f32 v[30:31], v[30:31], v[4:5] op_sel_hi:[1,0]
    v_pk_mul_f32 v[32:33], v[32:33], v[4:5] op_sel_hi:[1,0]
    v_pk_mul_f32 v[34:35], v[34:35], v[4:5] op_sel_hi:[1,0]
    v_pk_mul_f32 v[36:37], v[36:37], v[4:5] op_sel_hi:[1,0]
    v_pk_mul_f32 v[38:39], v[38:39], v[4:5] op_sel_hi:[1,0]
    v_pk_mul_f32 v[40:41], v[40:41], v[4:5] op_sel_hi:[1,0]
    v_pk_mul_f32 v[42:43], v[42:43], v[4:5] op_sel_hi:[1,0]
    v_pk_mul_f32 v[44:45], v[44:45], v[4:5] op_sel_hi:[1,0]
    v_pk_mul_f32 v[46:47], v[46:47], v[4:5] op_sel_hi:[1,0]
L_nr1:
    v_fma_f32 v4, v2, s34, -v8
    v_exp_f32 v4, v4
    s_waitcnt vmcnt(15)
    v_add_f32 v9, v9, v4
    v_lshlrev_b32 v252, 16, v60
    v_and_b32 v253, s33, v60
    v_pk_fma_f32 v[24:25], v[252:253], v[4:5], v[24:25] op_sel_hi:[1,0,1]
    v_lshlrev_b32 v254, 16, v61
    v_and_b32 v255, s33, v61
    v_pk_fma_f32 v[26:27], v[254:255], v[4:5], v[26:27] op_sel_hi:[1,0,1]
    v_lshlrev_b32 v252, 16, v62
    v_and_b32 v253, s33, v62
    v_pk_fma_f32 v[28:29], v[252:253], v[4:5], v[28:29] op_sel_hi:[1,0,1]
    v_lshlrev_b32 v254, 16, v63
    v_and_b32 v255, s33, v63
    v_pk_fma_f32 v[30:31], v[254:255], v[4:5], v[30:31] op_sel_hi:[1,0,1]
    v_lshlrev_b32 v252, 16, v64
    v_and_b32 v253, s33, v64
    v_pk_fma_f32 v[32:33], v[252:253], v[4:5], v[32:33] op_sel_hi:[1,0,1]
    v_lshlrev_b32 v254, 16, v65
    v_and_b32 v255, s33, v65
    v_pk_fma_f32 v[34:35], v[254:255], v[4:5], v[34:35] op_sel_hi:[1,0,1]
    v_lshlrev_b32 v252, 16, v66
    v_and_b32 v253, s33, v66
    v_pk_fma_f32 v[36:37], v[252:253], v[4:5], v[36:37] op_sel_hi:[1,0,1]
    v_lshlrev_b32 v254, 16, v67
    v_and_b32 v255, s33, v67
    v_pk_fma_f32 v[38:39], v[254:255], v[4:5], v[38:39] op_sel_hi:[1,0,1]
    v_lshlrev_b32 v252, 16, v68
    v_and_b32 v253, s33, v68
    v_pk_fma_f32 v[40:41], v[252:253], v[4:5], v[40:41] op_sel_hi:[1,0,1]
    v_lshlrev_b32 v254, 16, v69
    v_and_b32 v255, s33, v69
    v_pk_fma_f32 v[42:43], v[254:255], v[4:5], v[42:43] op_sel_hi:[1,0,1]
    v_lshlrev_b32 v252, 16, v70
    v_and_b32 v253, s33, v70
    v_pk_fma_f32 v[44:45], v[252:253], v[4:5], v[44:45] op_sel_hi:[1,0,1]
    v_lshlrev_b32 v254, 16, v71
    v_and_b32 v255, s33, v71
    v_pk_fma_f32 v[46:47], v[254:255], v[4:5], v[46:47] op_sel_hi:[1,0,1]
    buffer_load_dwordx4 v[60:63], v1, s[12:15], s24 offen offset:0 nt
    buffer_load_dwordx4 v[64:67], v1, s[12:15], s24 offen offset:128 nt
    buffer_load_dwordx4 v[68:71], v1, s[12:15], s24 offen offset:256 nt
L_se0:
    s_cmp_lg_u32 s29, 0
    s_cbranch_scc1 L_void1
    s_mov_b64 exec, 1
    ds_add_rtn_u32 v10, v241, v11 offset:388
    s_waitcnt lgkmcnt(0)
L_pop1:
    ds_read_b32 v5, v10 offset:10752
    s_waitcnt lgkmcnt(0)
    v_readfirstlane_b32 s28, v5
    s_cmp_lt_i32 s28, 0
    s_cbranch_scc1 L_pop1
    s_mov_b64 exec, -1
    s_cmp_lg_u32 s28, 0x7fffffff
    s_cbranch_scc1 L_go1
    s_mov_b32 s29, 1
L_void1:
    s_cmp_eq_u32 s29, 4
    s_cbranch_scc1 L_done
    s_add_u32 s29, s29, 1
    s_mov_b32 s10, 0
    s_mov_b32 s14, 0
    s_mov_b32 s28, 0
L_go1:
    s_mov_b32 s23, s21
    s_and_b32 s25, s28, 3
    s_cselect_b32 s24, 3072, 0
    s_cselect_b32 s21, 0x7ff, 0
    s_and_b32 s21, s21, s28
    s_sub_u32 s28, s28, s21
    s_add_u32 s24, s24, s28
    s_cmp_eq_u32 s25, 2
    s_cselect_b64 s[8:9], s[40:41], s[38:39]
    s_cmp_eq_u32 s25, 1
    s_cselect_b64 s[12:13], s[38:39], s[40:41]
    s_and_b32 s25, s23, 3
    s_cbranch_scc1 L_sp1
    s_waitcnt vmcnt(15)
    v_dot2_f32_bf16 v2, v72, v12, 0
    v_dot2_f32_bf16 v3, v73, v13, 0
    v_dot2_f32_bf16 v2, v74, v14, v2
    v_dot2_f32_bf16 v3, v75, v15, v3
    v_dot2_f32_bf16 v2, v76, v16, v2
    v_dot2_f32_bf16 v3, v77, v17, v3
    v_dot2_f32_bf16 v2, v78, v18, v2
    v_dot2_f32_bf16 v3, v79, v19, v3
    v_dot2_f32_bf16 v2, v80, v20, v2
    v_dot2_f32_bf16 v3, v81, v21, v3
    v_dot2_f32_bf16 v2, v82, v22, v2
    v_dot2_f32_bf16 v3, v83, v23, v3
    buffer_load_dwordx4 v[72:75], v1, s[8:11], s28 offen offset:0 nt
    buffer_load_dwordx4 v[76:79], v1, s[8:11], s28 offen offset:128 nt
    buffer_load_dwordx4 v[80:83], v1, s[8:11], s28 offen offset:256 nt
    v_add_f32 v2, v2, v3
    s_nop 1
    v_add_f32_dpp v2, v2, v2 quad_perm:[1,0,3,2] row_mask:0xf bank_mask:0xf
    s_nop 1
    v_add_f32_dpp v2, v2, v2 quad_perm:[2,3,0,1] row_mask:0xf bank_mask:0xf
    s_nop 1
    v_add_f32_dpp v2, v2, v2 row_half_mirror row_mask:0xf bank_mask:0xf
    v_cmp_gt_f32 vcc, v2, v7
    s_cbranch_vccz L_nr2
    v_max_f32 v3, v2, v7
    s_nop 1
    v_max_f32_dpp v3, v3, v3 row_ror:8 row_mask:0xf bank_mask:0xf
    v_mov_b32 v5, v3
    s_nop 1
    v_permlane16_swap_b32 v5, v3
    v_max_f32 v3, v3, v5
    v_mov_b32 v5, v3
    s_nop 1
    v_permlane32_swap_b32 v5, v3
    v_max_f32 v3, v3, v5
    v_sub_f32 v5, v7, v3
    v_mul_f32 v5, s34, v5
    v_exp_f32 v4, v5
    v_mov_b32 v7, v3
    v_mul_f32 v8, s34, v3
    v_mul_f32 v9, v9, v4
    v_pk_mul_f32 v[24:25], v[24:25], v[4:5] op_sel_hi:[1,0]
    v_pk_mul_f32 v[26:27], v[26:27], v[4:5] op_sel_hi:[1,0]
    v_pk_mul_f32 v[28:29], v[28:29], v[4:5] op_sel_hi:[1,0]
    v_pk_mul_f32 v[30:31], v[30:31], v[4:5] op_sel_hi:[1,0]
    v_pk_mul_f32 v[32:33], v[32:33], v[4:5] op_sel_hi:[1,0]
    v_pk_mul_f32 v[34:35], v[34:35], v[4:5] op_sel_hi:[1,0]
    v_pk_mul_f32 v[36:37], v[36:37], v[4:5] op_sel_hi:[1,0]
    v_pk_mul_f32 v[38:39], v[38:39], v[4:5] op_sel_hi:[1,0]
    v_pk_mul_f32 v[40:41], v[40:41], v[4:5] op_sel_hi:[1,0]
    v_pk_mul_f32 v[42:43], v[42:43], v[4:5] op_sel_hi:[1,0]
    v_pk_mul_f32 v[44:45], v[44:45], v[4:5] op_sel_hi:[1,0]
    v_pk_mul_f32 v[46:47], v[46:47], v[4:5] op_sel_hi:[1,0]
L_nr2:
    v_fma_f32 v4, v2, s34, -v8
    v_exp_f32 v4, v4
    s_waitcnt vmcnt(15)
    v_add_f32 v9, v9, v4
    v_lshlrev_b32 v252, 16, v84
    v_and_b32 v253, s33, v84
    v_pk_fma_f32 v[24:25], v[252:253], v[4:5], v[24:25] op_sel_hi:[1,0,1]
    v_lshlrev_b32 v254, 16, v85
    v_and_b32 v255, s33, v85
    v_pk_fma_f32 v[26:27], v[254:255], v[4:5], v[26:27] op_sel_hi:[1,0,1]
    v_lshlrev_b32 v252, 16, v86
    v_and_b32 v253, s33, v86
    v_pk_fma_f32 v[28:29], v[252:253], v[4:5], v[28:29] op_sel_hi:[1,0,1]
    v_lshlrev_b32 v254, 16, v87
    v_and_b32 v255, s33, v87
    v_pk_fma_f32 v[30:31], v[254:255], v[4:5], v[30:31] op_sel_hi:[1,0,1]
    v_lshlrev_b32 v252, 16, v88
    v_and_b32 v253, s33, v88
    v_pk_fma_f32 v[32:33], v[252:253], v[4:5], v[32:33] op_sel_hi:[1,0,1]
    v_lshlrev_b32 v254, 16, v89
    v_and_b32 v255, s33, v89
    v_pk_fma_f32 v[34:35], v[254:255], v[4:5], v[34:35] op_sel_hi:[1,0,1]
    v_lshlrev_b32 v252, 16, v90
    v_and_b32 v253, s33, v90
    v_pk_fma_f32 v[36:37], v[252:253], v[4:5], v[36:37] op_sel_hi:[1,0,1]
    v_lshlrev_b32 v254, 16, v91
    v_and_b32 v255, s33, v91
    v_pk_fma_f32 v[38:39], v[254:255], v[4:5], v[38:39] op_sel_hi:[1,0,1]
    v_lshlrev_b32 v252, 16, v92
    v_and_b32 v253, s33, v92
    v_pk_fma_f32 v[40:41], v[252:253], v[4:5], v[40:41] op_sel_hi:[1,0,1]
    v_lshlrev_b32 v254, 16, v93
    v_and_b32 v255, s33, v93
    v_pk_fma_f32 v[42:43], v[254:255], v[4:5], v[42:43] op_sel_hi:[1,0,1]
    v_lshlrev_b32 v252, 16, v94
    v_and_b32 v253, s33, v94
    v_pk_fma_f32 v[44:45], v[252:253], v[4:5], v[44:45] op_sel_hi:[1,0,1]
    v_lshlrev_b32 v254, 16, v95
    v_and_b32 v255, s33, v95
    v_pk_fma_f32 v[46:47], v[254:255], v[4:5], v[46:47] op_sel_hi:[1,0,1]
    buffer_load_dwordx4 v[84:87], v1, s[12:15], s24 offen offset:0 nt
    buffer_load_dwordx4 v[88:91], v1, s[12:15], s24 offen offset:128 nt
    buffer_load_dwordx4 v[92:95], v1, s[12:15], s24 offen offset:256 nt
L_se1:
    s_cmp_lg_u32 s29, 0
    s_cbranch_scc1 L_void2
    s_mov_b64 exec, 1
    ds_add_rtn_u32 v10, v241, v11 offset:388
    s_waitcnt lgkmcnt(0)
L_pop2:
    ds_read_b32 v5, v10 offset:10752
    s_waitcnt lgkmcnt(0)
    v_readfirstlane_b32 s28, v5
    s_cmp_lt_i32 s28, 0
    s_cbranch_scc1 L_pop2
    s_mov_b64 exec, -1
    s_cmp_lg_u32 s28, 0x7fffffff
    s_cbranch_scc1 L_go2
    s_mov_b32 s29, 1
L_void2:
    s_cmp_eq_u32 s29, 4
    s_cbranch_scc1 L_done
    s_add_u32 s29, s29, 1
    s_mov_b32 s10, 0
    s_mov_b32 s14, 0
    s_mov_b32 s28, 0
L_go2:
    s_mov_b32 s23, s22
    s_and_b32 s25, s28, 3
    s_cselect_b32 s24, 3072, 0
    s_cselect_b32 s22, 0x7ff, 0
    s_and_b32 s22, s22, s28
    s_sub_u32 s28, s28, s22
    s_add_u32 s24, s24, s28
    s_cmp_eq_u32 s25, 2
    s_cselect_b64 s[8:9], s[40:41], s[38:39]
    s_cmp_eq_u32 s25, 1
    s_cselect_b64 s[12:13], s[38:39], s[40:41]
    s_and_b32 s25, s23, 3
    s_cbranch_scc1 L_sp2
    s_waitcnt vmcnt(15)
    v_dot2_f32_bf16 v2, v96, v12, 0
    v_dot2_f32_bf16 v3, v97, v13, 0
    v_dot2_f32_bf16 v2, v98, v14, v2
    v_dot2_f32_bf16 v3, v99, v15, v3
    v_dot2_f32_bf16 v2, v100, v16, v2
    v_dot2_f32_bf16 v3, v101, v17, v3
    v_dot2_f32_bf16 v2, v102, v18, v2
    v_dot2_f32_bf16 v3, v103, v19, v3
    v_dot2_f32_bf16 v2, v104, v20, v2
    v_dot2_f32_bf16 v3, v105, v21, v3
    v_dot2_f32_bf16 v2, v106, v22, v2
    v_dot2_f32_bf16 v3, v107, v23, v3
    buffer_load_dwordx4 v[96:99], v1, s[8:11], s28 offen offset:0 nt
    buffer_load_dwordx4 v[100:103], v1, s[8:11], s28 offen offset:128 nt
    buffer_load_dwordx4 v[104:107], v1, s[8:11], s28 offen offset:256 nt
    v_add_f32 v2, v2, v3
    s_nop 1
    v_add_f32_dpp v2, v2, v2 quad_perm:[1,0,3,2] row_mask:0xf bank_mask:0xf
    s_nop 1
    v_add_f32_dpp v2, v2, v2 quad_perm:[2,3,0,1] row_mask:0xf bank_mask:0xf
    s_nop 1
    v_add_f32_dpp v2, v2, v2 row_half_mirror row_mask:0xf bank_mask:0xf
    v_cmp_gt_f32 vcc, v2, v7
    s_cbranch_vccz L_nr3
    v_max_f32 v3, v2, v7
    s_nop 1
    v_max_f32_dpp v3, v3, v3 row_ror:8 row_mask:0xf bank_mask:0xf
    v_mov_b32 v5, v3
    s_nop 1
    v_permlane16_swap_b32 v5, v3
    v_max_f32 v3, v3, v5
    v_mov_b32 v5, v3
    s_nop 1
    v_permlane32_swap_b32 v5, v3
    v_max_f32 v3, v3, v5
    v_sub_f32 v5, v7, v3
    v_mul_f32 v5, s34, v5
    v_exp_f32 v4, v5
    v_mov_b32 v7, v3
    v_mul_f32 v8, s34, v3
    v_mul_f32 v9, v9, v4
    v_pk_mul_f32 v[24:25], v[24:25], v[4:5] op_sel_hi:[1,0]
    v_pk_mul_f32 v[26:27], v[26:27], v[4:5] op_sel_hi:[1,0]
    v_pk_mul_f32 v[28:29], v[28:29], v[4:5] op_sel_hi:[1,0]
    v_pk_mul_f32 v[30:31], v[30:31], v[4:5] op_sel_hi:[1,0]
    v_pk_mul_f32 v[32:33], v[32:33], v[4:5] op_sel_hi:[1,0]
    v_pk_mul_f32 v[34:35], v[34:35], v[4:5] op_sel_hi:[1,0]
    v_pk_mul_f32 v[36:37], v[36:37], v[4:5] op_sel_hi:[1,0]
    v_pk_mul_f32 v[38:39], v[38:39], v[4:5] op_sel_hi:[1,0]
    v_pk_mul_f32 v[40:41], v[40:41], v[4:5] op_sel_hi:[1,0]
    v_pk_mul_f32 v[42:43], v[42:43], v[4:5] op_sel_hi:[1,0]
    v_pk_mul_f32 v[44:45], v[44:45], v[4:5] op_sel_hi:[1,0]
    v_pk_mul_f32 v[46:47], v[46:47], v[4:5] op_sel_hi:[1,0]
L_nr3:
    v_fma_f32 v4, v2, s34, -v8
    v_exp_f32 v4, v4
    s_waitcnt vmcnt(15)
    v_add_f32 v9, v9, v4
    v_lshlrev_b32 v252, 16, v108
    v_and_b32 v253, s33, v108
    v_pk_fma_f32 v[24:25], v[252:253], v[4:5], v[24:25] op_sel_hi:[1,0,1]
    v_lshlrev_b32 v254, 16, v109
    v_and_b32 v255, s33, v109
    v_pk_fma_f32 v[26:27], v[254:255], v[4:5], v[26:27] op_sel_hi:[1,0,1]
    v_lshlrev_b32 v252, 16, v110
    v_and_b32 v253, s33, v110
    v_pk_fma_f32 v[28:29], v[252:253], v[4:5], v[28:29] op_sel_hi:[1,0,1]
    v_lshlrev_b32 v254, 16, v111
    v_and_b32 v255, s33, v111
    v_pk_fma_f32 v[30:31], v[254:255], v[4:5], v[30:31] op_sel_hi:[1,0,1]
    v_lshlrev_b32 v252, 16, v112
    v_and_b32 v253, s33, v112
    v_pk_fma_f32 v[32:33], v[252:253], v[4:5], v[32:33] op_sel_hi:[1,0,1]
    v_lshlrev_b32 v254, 16, v113
    v_and_b32 v255, s33, v113
    v_pk_fma_f32 v[34:35], v[254:255], v[4:5], v[34:35] op_sel_hi:[1,0,1]
    v_lshlrev_b32 v252, 16, v114
    v_and_b32 v253, s33, v114
    v_pk_fma_f32 v[36:37], v[252:253], v[4:5], v[36:37] op_sel_hi:[1,0,1]
    v_lshlrev_b32 v254, 16, v115
    v_and_b32 v255, s33, v115
    v_pk_fma_f32 v[38:39], v[254:255], v[4:5], v[38:39] op_sel_hi:[1,0,1]
    v_lshlrev_b32 v252, 16, v116
    v_and_b32 v253, s33, v116
    v_pk_fma_f32 v[40:41], v[252:253], v[4:5], v[40:41] op_sel_hi:[1,0,1]
    v_lshlrev_b32 v254, 16, v117
    v_and_b32 v255, s33, v117
    v_pk_fma_f32 v[42:43], v[254:255], v[4:5], v[42:43] op_sel_hi:[1,0,1]
    v_lshlrev_b32 v252, 16, v118
    v_and_b32 v253, s33, v118
    v_pk_fma_f32 v[44:45], v[252:253], v[4:5], v[44:45] op_sel_hi:[1,0,1]
    v_lshlrev_b32 v254, 16, v119
    v_and_b32 v255, s33, v119
    v_pk_fma_f32 v[46:47], v[254:255], v[4:5], v[46:47] op_sel_hi:[1,0,1]
    buffer_load_dwordx4 v[108:111], v1, s[12:15], s24 offen offset:0 nt
    buffer_load_dwordx4 v[112:115], v1, s[12:15], s24 offen offset:128 nt
    buffer_load_dwordx4 v[116:119], v1, s[12:15], s24 offen offset:256 nt
L_se2:
    s_cmp_lg_u32 s30, 1
    s_cbranch_scc1 L_loop
    s_cmp_lt_u32 s3, 4
    s_cbranch_scc1 L_loop
L_hi:
    s_waitcnt vmcnt(45)
    v_dot2_f32_bf16 v2, v120, v12, 0
    v_dot2_f32_bf16 v3, v121, v13, 0
    v_dot2_f32_bf16 v2, v122, v14, v2
    v_dot2_f32_bf16 v3, v123, v15, v3
    v_dot2_f32_bf16 v2, v124, v16, v2
    v_dot2_f32_bf16 v3, v125, v17, v3
    v_dot2_f32_bf16 v2, v126, v18, v2
    v_dot2_f32_bf16 v3, v127, v19, v3
    v_dot2_f32_bf16 v2, v128, v20, v2
    v_dot2_f32_bf16 v3, v129, v21, v3
    v_dot2_f32_bf16 v2, v130, v22, v2
    v_dot2_f32_bf16 v3, v131, v23, v3
    s_nop 2
    v_add_f32 v2, v2, v3
    s_nop 1
    v_add_f32_dpp v2, v2, v2 quad_perm:[1,0,3,2] row_mask:0xf bank_mask:0xf
    s_nop 1
    v_add_f32_dpp v2, v2, v2 quad_perm:[2,3,0,1] row_mask:0xf bank_mask:0xf
    s_nop 1
    v_add_f32_dpp v2, v2, v2 row_half_mirror row_mask:0xf bank_mask:0xf
    v_cmp_gt_f32 vcc, v2, v7
    s_cbranch_vccz L_nr4
    v_max_f32 v3, v2, v7
    s_nop 1
    v_max_f32_dpp v3, v3, v3 row_ror:8 row_mask:0xf bank_mask:0xf
    v_mov_b32 v5, v3
    s_nop 1
    v_permlane16_swap_b32 v5, v3
    v_max_f32 v3, v3, v5
    v_mov_b32 v5, v3
    s_nop 1
    v_permlane32_swap_b32 v5, v3
    v_max_f32 v3, v3, v5
    v_sub_f32 v5, v7, v3
    v_mul_f32 v5, s34, v5
    v_exp_f32 v4, v5
    v_mov_b32 v7, v3
    v_mul_f32 v8, s34, v3
    v_mul_f32 v9, v9, v4
    v_pk_mul_f32 v[24:25], v[24:25], v[4:5] op_sel_hi:[1,0]
    v_pk_mul_f32 v[26:27], v[26:27], v[4:5] op_sel_hi:[1,0]
    v_pk_mul_f32 v[28:29], v[28:29], v[4:5] op_sel_hi:[1,0]
    v_pk_mul_f32 v[30:31], v[30:31], v[4:5] op_sel_hi:[1,0]
    v_pk_mul_f32 v[32:33], v[32:33], v[4:5] op_sel_hi:[1,0]
    v_pk_mul_f32 v[34:35], v[34:35], v[4:5] op_sel_hi:[1,0]
    v_pk_mul_f32 v[36:37], v[36:37], v[4:5] op_sel_hi:[1,0]
    v_pk_mul_f32 v[38:39], v[38:39], v[4:5] op_sel_hi:[1,0]
    v_pk_mul_f32 v[40:41], v[40:41], v[4:5] op_sel_hi:[1,0]
    v_pk_mul_f32 v[42:43], v[42:43], v[4:5] op_sel_hi:[1,0]
    v_pk_mul_f32 v[44:45], v[44:45], v[4:5] op_sel_hi:[1,0]
    v_pk_mul_f32 v[46:47], v[46:47], v[4:5] op_sel_hi:[1,0]
L_nr4:
    v_fma_f32 v4, v2, s34, -v8
    v_exp_f32 v4, v4
    s_waitcnt vmcnt(42)
    v_add_f32 v9, v9, v4
    v_lshlrev_b32 v252, 16, v132
    v_and_b32 v253, s33, v132
    v_pk_fma_f32 v[24:25], v[252:253], v[4:5], v[24:25] op_sel_hi:[1,0,1]
    v_lshlrev_b32 v254, 16, v133
    v_and_b32 v255, s33, v133
    v_pk_fma_f32 v[26:27], v[254:255], v[4:5], v[26:27] op_sel_hi:[1,0,1]
    v_lshlrev_b32 v252, 16, v134
    v_and_b32 v253, s33, v134
    v_pk_fma_f32 v[28:29], v[252:253], v[4:5], v[28:29] op_sel_hi:[1,0,1]
    v_lshlrev_b32 v254, 16, v135
    v_and_b32 v255, s33, v135
    v_pk_fma_f32 v[30:31], v[254:255], v[4:5], v[30:31] op_sel_hi:[1,0,1]
    v_lshlrev_b32 v252, 16, v136
    v_and_b32 v253, s33, v136
    v_pk_fma_f32 v[32:33], v[252:253], v[4:5], v[32:33] op_sel_hi:[1,0,1]
    v_lshlrev_b32 v254, 16, v137
    v_and_b32 v255, s33, v137
    v_pk_fma_f32 v[34:35], v[254:255], v[4:5], v[34:35] op_sel_hi:[1,0,1]
    v_lshlrev_b32 v252, 16, v138
    v_and_b32 v253, s33, v138
    v_pk_fma_f32 v[36:37], v[252:253], v[4:5], v[36:37] op_sel_hi:[1,0,1]
    v_lshlrev_b32 v254, 16, v139
    v_and_b32 v255, s33, v139
    v_pk_fma_f32 v[38:39], v[254:255], v[4:5], v[38:39] op_sel_hi:[1,0,1]
    v_lshlrev_b32 v252, 16, v140
    v_and_b32 v253, s33, v140
    v_pk_fma_f32 v[40:41], v[252:253], v[4:5], v[40:41] op_sel_hi:[1,0,1]
    v_lshlrev_b32 v254, 16, v141
    v_and_b32 v255, s33, v141
    v_pk_fma_f32 v[42:43], v[254:255], v[4:5], v[42:43] op_sel_hi:[1,0,1]
    v_lshlrev_b32 v252, 16, v142
    v_and_b32 v253, s33, v142
    v_pk_fma_f32 v[44:45], v[252:253], v[4:5], v[44:45] op_sel_hi:[1,0,1]
    v_lshlrev_b32 v254, 16, v143
    v_and_b32 v255, s33, v143
    v_pk_fma_f32 v[46:47], v[254:255], v[4:5], v[46:47] op_sel_hi:[1,0,1]
    s_waitcnt vmcnt(39)
    v_dot2_f32_bf16 v2, v144, v12, 0
    v_dot2_f32_bf16 v3, v145, v13, 0
    v_dot2_f32_bf16 v2, v146, v14, v2
    v_dot2_f32_bf16 v3, v147, v15, v3
    v_dot2_f32_bf16 v2, v148, v16, v2
    v_dot2_f32_bf16 v3, v149, v17, v3
    v_dot2_f32_bf16 v2, v150, v18, v2
    v_dot2_f32_bf16 v3, v151, v19, v3
    v_dot2_f32_bf16 v2, v152, v20, v2
    v_dot2_f32_bf16 v3, v153, v21, v3
    v_dot2_f32_bf16 v2, v154, v22, v2
    v_dot2_f32_bf16 v3, v155, v23, v3
    s_nop 2
    v_add_f32 v2, v2, v3
    s_nop 1
    v_add_f32_dpp v2, v2, v2 quad_perm:[1,0,3,2] row_mask:0xf bank_mask:0xf
    s_nop 1
    v_add_f32_dpp v2, v2, v2 quad_perm:[2,3,0,1] row_mask:0xf bank_mask:0xf
    s_nop 1
    v_add_f32_dpp v2, v2, v2 row_half_mirror row_mask:0xf bank_mask:0xf
    v_cmp_gt_f32 vcc, v2, v7
    s_cbranch_vccz L_nr5
    v_max_f32 v3, v2, v7
    s_nop 1
    v_max_f32_dpp v3, v3, v3 row_ror:8 row_mask:0xf bank_mask:0xf
    v_mov_b32 v5, v3
    s_nop 1
    v_permlane16_swap_b32 v5, v3
    v_max_f32 v3, v3, v5
    v_mov_b32 v5, v3
    s_nop 1
    v_permlane32_swap_b32 v5, v3
    v_max_f32 v3, v3, v5
    v_sub_f32 v5, v7, v3
    v_mul_f32 v5, s34, v5
    v_exp_f32 v4, v5
    v_mov_b32 v7, v3
    v_mul_f32 v8, s34, v3
    v_mul_f32 v9, v9, v4
    v_pk_mul_f32 v[24:25], v[24:25], v[4:5] op_sel_hi:[1,0]
    v_pk_mul_f32 v[26:27], v[26:27], v[4:5] op_sel_hi:[1,0]
    v_pk_mul_f32 v[28:29], v[28:29], v[4:5] op_sel_hi:[1,0]
    v_pk_mul_f32 v[30:31], v[30:31], v[4:5] op_sel_hi:[1,0]
    v_pk_mul_f32 v[32:33], v[32:33], v[4:5] op_sel_hi:[1,0]
    v_pk_mul_f32 v[34:35], v[34:35], v[4:5] op_sel_hi:[1,0]
    v_pk_mul_f32 v[36:37], v[36:37], v[4:5] op_sel_hi:[1,0]
    v_pk_mul_f32 v[38:39], v[38:39], v[4:5] op_sel_hi:[1,0]
    v_pk_mul_f32 v[40:41], v[40:41], v[4:5] op_sel_hi:[1,0]
    v_pk_mul_f32 v[42:43], v[42:43], v[4:5] op_sel_hi:[1,0]
    v_pk_mul_f32 v[44:45], v[44:45], v[4:5] op_sel_hi:[1,0]
    v_pk_mul_f32 v[46:47], v[46:47], v[4:5] op_sel_hi:[1,0]
L_nr5:
    v_fma_f32 v4, v2, s34, -v8
    v_exp_f32 v4, v4
    s_waitcnt vmcnt(36)
    v_add_f32 v9, v9, v4
    v_lshlrev_b32 v252, 16, v156
    v_and_b32 v253, s33, v156
    v_pk_fma_f32 v[24:25], v[252:253], v[4:5], v[24:25] op_sel_hi:[1,0,1]
    v_lshlrev_b32 v254, 16, v157
    v_and_b32 v255, s33, v157
    v_pk_fma_f32 v[26:27], v[254:255], v[4:5], v[26:27] op_sel_hi:[1,0,1]
    v_lshlrev_b32 v252, 16, v158
    v_and_b32 v253, s33, v158
    v_pk_fma_f32 v[28:29], v[252:253], v[4:5], v[28:29] op_sel_hi:[1,0,1]
    v_lshlrev_b32 v254, 16, v159
    v_and_b32 v255, s33, v159
    v_pk_fma_f32 v[30:31], v[254:255], v[4:5], v[30:31] op_sel_hi:[1,0,1]
    v_lshlrev_b32 v252, 16, v160
    v_and_b32 v253, s33, v160
    v_pk_fma_f32 v[32:33], v[252:253], v[4:5], v[32:33] op_sel_hi:[1,0,1]
    v_lshlrev_b32 v254, 16, v161
    v_and_b32 v255, s33, v161
    v_pk_fma_f32 v[34:35], v[254:255], v[4:5], v[34:35] op_sel_hi:[1,0,1]
    v_lshlrev_b32 v252, 16, v162
    v_and_b32 v253, s33, v162
    v_pk_fma_f32 v[36:37], v[252:253], v[4:5], v[36:37] op_sel_hi:[1,0,1]
    v_lshlrev_b32 v254, 16, v163
    v_and_b32 v255, s33, v163
    v_pk_fma_f32 v[38:39], v[254:255], v[4:5], v[38:39] op_sel_hi:[1,0,1]
    v_lshlrev_b32 v252, 16, v164
    v_and_b32 v253, s33, v164
    v_pk_fma_f32 v[40:41], v[252:253], v[4:5], v[40:41] op_sel_hi:[1,0,1]
    v_lshlrev_b32 v254, 16, v165
    v_and_b32 v255, s33, v165
    v_pk_fma_f32 v[42:43], v[254:255], v[4:5], v[42:43] op_sel_hi:[1,0,1]
    v_lshlrev_b32 v252, 16, v166
    v_and_b32 v253, s33, v166
    v_pk_fma_f32 v[44:45], v[252:253], v[4:5], v[44:45] op_sel_hi:[1,0,1]
    v_lshlrev_b32 v254, 16, v167
    v_and_b32 v255, s33, v167
    v_pk_fma_f32 v[46:47], v[254:255], v[4:5], v[46:47] op_sel_hi:[1,0,1]
    s_waitcnt vmcnt(33)
    v_dot2_f32_bf16 v2, v168, v12, 0
    v_dot2_f32_bf16 v3, v169, v13, 0
    v_dot2_f32_bf16 v2, v170, v14, v2
    v_dot2_f32_bf16 v3, v171, v15, v3
    v_dot2_f32_bf16 v2, v172, v16, v2
    v_dot2_f32_bf16 v3, v173, v17, v3
    v_dot2_f32_bf16 v2, v174, v18, v2
    v_dot2_f32_bf16 v3, v175, v19, v3
    v_dot2_f32_bf16 v2, v176, v20, v2
    v_dot2_f32_bf16 v3, v177, v21, v3
    v_dot2_f32_bf16 v2, v178, v22, v2
    v_dot2_f32_bf16 v3, v179, v23, v3
    s_nop 2
    v_add_f32 v2, v2, v3
    s_nop 1
    v_add_f32_dpp v2, v2, v2 quad_perm:[1,0,3,2] row_mask:0xf bank_mask:0xf
    s_nop 1
    v_add_f32_dpp v2, v2, v2 quad_perm:[2,3,0,1] row_mask:0xf bank_mask:0xf
    s_nop 1
    v_add_f32_dpp v2, v2, v2 row_half_mirror row_mask:0xf bank_mask:0xf
    v_cmp_gt_f32 vcc, v2, v7
    s_cbranch_vccz L_nr6
    v_max_f32 v3, v2, v7
    s_nop 1
    v_max_f32_dpp v3, v3, v3 row_ror:8 row_mask:0xf bank_mask:0xf
    v_mov_b32 v5, v3
    s_nop 1
    v_permlane16_swap_b32 v5, v3
    v_max_f32 v3, v3, v5
    v_mov_b32 v5, v3
    s_nop 1
    v_permlane32_swap_b32 v5, v3
    v_max_f32 v3, v3, v5
    v_sub_f32 v5, v7, v3
    v_mul_f32 v5, s34, v5
    v_exp_f32 v4, v5
    v_mov_b32 v7, v3
    v_mul_f32 v8, s34, v3
    v_mul_f32 v9, v9, v4
    v_pk_mul_f32 v[24:25], v[24:25], v[4:5] op_sel_hi:[1,0]
    v_pk_mul_f32 v[26:27], v[26:27], v[4:5] op_sel_hi:[1,0]
    v_pk_mul_f32 v[28:29], v[28:29], v[4:5] op_sel_hi:[1,0]
    v_pk_mul_f32 v[30:31], v[30:31], v[4:5] op_sel_hi:[1,0]
    v_pk_mul_f32 v[32:33], v[32:33], v[4:5] op_sel_hi:[1,0]
    v_pk_mul_f32 v[34:35], v[34:35], v[4:5] op_sel_hi:[1,0]
    v_pk_mul_f32 v[36:37], v[36:37], v[4:5] op_sel_hi:[1,0]
    v_pk_mul_f32 v[38:39], v[38:39], v[4:5] op_sel_hi:[1,0]
    v_pk_mul_f32 v[40:41], v[40:41], v[4:5] op_sel_hi:[1,0]
    v_pk_mul_f32 v[42:43], v[42:43], v[4:5] op_sel_hi:[1,0]
    v_pk_mul_f32 v[44:45], v[44:45], v[4:5] op_sel_hi:[1,0]
    v_pk_mul_f32 v[46:47], v[46:47], v[4:5] op_sel_hi:[1,0]
L_nr6:
    v_fma_f32 v4, v2, s34, -v8
    v_exp_f32 v4, v4
    s_waitcnt vmcnt(30)
    v_add_f32 v9, v9, v4
    v_lshlrev_b32 v252, 16, v180
    v_and_b32 v253, s33, v180
    v_pk_fma_f32 v[24:25], v[252:253], v[4:5], v[24:25] op_sel_hi:[1,0,1]
    v_lshlrev_b32 v254, 16, v181
    v_and_b32 v255, s33, v181
    v_pk_fma_f32 v[26:27], v[254:255], v[4:5], v[26:27] op_sel_hi:[1,0,1]
    v_lshlrev_b32 v252, 16, v182
    v_and_b32 v253, s33, v182
    v_pk_fma_f32 v[28:29], v[252:253], v[4:5], v[28:29] op_sel_hi:[1,0,1]
    v_lshlrev_b32 v254, 16, v183
    v_and_b32 v255, s33, v183
    v_pk_fma_f32 v[30:31], v[254:255], v[4:5], v[30:31] op_sel_hi:[1,0,1]
    v_lshlrev_b32 v252, 16, v184
    v_and_b32 v253, s33, v184
    v_pk_fma_f32 v[32:33], v[252:253], v[4:5], v[32:33] op_sel_hi:[1,0,1]
    v_lshlrev_b32 v254, 16, v185
    v_and_b32 v255, s33, v185
    v_pk_fma_f32 v[34:35], v[254:255], v[4:5], v[34:35] op_sel_hi:[1,0,1]
    v_lshlrev_b32 v252, 16, v186
    v_and_b32 v253, s33, v186
    v_pk_fma_f32 v[36:37], v[252:253], v[4:5], v[36:37] op_sel_hi:[1,0,1]
    v_lshlrev_b32 v254, 16, v187
    v_and_b32 v255, s33, v187
    v_pk_fma_f32 v[38:39], v[254:255], v[4:5], v[38:39] op_sel_hi:[1,0,1]
    v_lshlrev_b32 v252, 16, v188
    v_and_b32 v253, s33, v188
    v_pk_fma_f32 v[40:41], v[252:253], v[4:5], v[40:41] op_sel_hi:[1,0,1]
    v_lshlrev_b32 v254, 16, v189
    v_and_b32 v255, s33, v189
    v_pk_fma_f32 v[42:43], v[254:255], v[4:5], v[42:43] op_sel_hi:[1,0,1]
    v_lshlrev_b32 v252, 16, v190
    v_and_b32 v253, s33, v190
    v_pk_fma_f32 v[44:45], v[252:253], v[4:5], v[44:45] op_sel_hi:[1,0,1]
    v_lshlrev_b32 v254, 16, v191
    v_and_b32 v255, s33, v191
    v_pk_fma_f32 v[46:47], v[254:255], v[4:5], v[46:47] op_sel_hi:[1,0,1]
    s_waitcnt vmcnt(27)
    v_dot2_f32_bf16 v2, v192, v12, 0
    v_dot2_f32_bf16 v3, v193, v13, 0
    v_dot2_f32_bf16 v2, v194, v14, v2
    v_dot2_f32_bf16 v3, v195, v15, v3
    v_dot2_f32_bf16 v2, v196, v16, v2
    v_dot2_f32_bf16 v3, v197, v17, v3
    v_dot2_f32_bf16 v2, v198, v18, v2
    v_dot2_f32_bf16 v3, v199, v19, v3
    v_dot2_f32_bf16 v2, v200, v20, v2
    v_dot2_f32_bf16 v3, v201, v21, v3
    v_dot2_f32_bf16 v2, v202, v22, v2
    v_dot2_f32_bf16 v3, v203, v23, v3
    s_nop 2
    v_add_f32 v2, v2, v3
    s_nop 1
    v_add_f32_dpp v2, v2, v2 quad_perm:[1,0,3,2] row_mask:0xf bank_mask:0xf
    s_nop 1
    v_add_f32_dpp v2, v2, v2 quad_perm:[2,3,0,1] row_mask:0xf bank_mask:0xf
    s_nop 1
    v_add_f32_dpp v2, v2, v2 row_half_mirror row_mask:0xf bank_mask:0xf
    v_cmp_gt_f32 vcc, v2, v7
    s_cbranch_vccz L_nr7
    v_max_f32 v3, v2, v7
    s_nop 1
    v_max_f32_dpp v3, v3, v3 row_ror:8 row_mask:0xf bank_mask:0xf
    v_mov_b32 v5, v3
    s_nop 1
    v_permlane16_swap_b32 v5, v3
    v_max_f32 v3, v3, v5
    v_mov_b32 v5, v3
    s_nop 1
    v_permlane32_swap_b32 v5, v3
    v_max_f32 v3, v3, v5
    v_sub_f32 v5, v7, v3
    v_mul_f32 v5, s34, v5
    v_exp_f32 v4, v5
    v_mov_b32 v7, v3
    v_mul_f32 v8, s34, v3
    v_mul_f32 v9, v9, v4
    v_pk_mul_f32 v[24:25], v[24:25], v[4:5] op_sel_hi:[1,0]
    v_pk_mul_f32 v[26:27], v[26:27], v[4:5] op_sel_hi:[1,0]
    v_pk_mul_f32 v[28:29], v[28:29], v[4:5] op_sel_hi:[1,0]
    v_pk_mul_f32 v[30:31], v[30:31], v[4:5] op_sel_hi:[1,0]
    v_pk_mul_f32 v[32:33], v[32:33], v[4:5] op_sel_hi:[1,0]
    v_pk_mul_f32 v[34:35], v[34:35], v[4:5] op_sel_hi:[1,0]
    v_pk_mul_f32 v[36:37], v[36:37], v[4:5] op_sel_hi:[1,0]
    v_pk_mul_f32 v[38:39], v[38:39], v[4:5] op_sel_hi:[1,0]
    v_pk_mul_f32 v[40:41], v[40:41], v[4:5] op_sel_hi:[1,0]
    v_pk_mul_f32 v[42:43], v[42:43], v[4:5] op_sel_hi:[1,0]
    v_pk_mul_f32 v[44:45], v[44:45], v[4:5] op_sel_hi:[1,0]
    v_pk_mul_f32 v[46:47], v[46:47], v[4:5] op_sel_hi:[1,0]
L_nr7:
    v_fma_f32 v4, v2, s34, -v8
    v_exp_f32 v4, v4
    s_waitcnt vmcnt(24)
    v_add_f32 v9, v9, v4
    v_lshlrev_b32 v252, 16, v204
    v_and_b32 v253, s33, v204
    v_pk_fma_f32 v[24:25], v[252:253], v[4:5], v[24:25] op_sel_hi:[1,0,1]
    v_lshlrev_b32 v254, 16, v205
    v_and_b32 v255, s33, v205
    v_pk_fma_f32 v[26:27], v[254:255], v[4:5], v[26:27] op_sel_hi:[1,0,1]
    v_lshlrev_b32 v252, 16, v206
    v_and_b32 v253, s33, v206
    v_pk_fma_f32 v[28:29], v[252:253], v[4:5], v[28:29] op_sel_hi:[1,0,1]
    v_lshlrev_b32 v254, 16, v207
    v_and_b32 v255, s33, v207
    v_pk_fma_f32 v[30:31], v[254:255], v[4:5], v[30:31] op_sel_hi:[1,0,1]
    v_lshlrev_b32 v252, 16, v208
    v_and_b32 v253, s33, v208
    v_pk_fma_f32 v[32:33], v[252:253], v[4:5], v[32:33] op_sel_hi:[1,0,1]
    v_lshlrev_b32 v254, 16, v209
    v_and_b32 v255, s33, v209
    v_pk_fma_f32 v[34:35], v[254:255], v[4:5], v[34:35] op_sel_hi:[1,0,1]
    v_lshlrev_b32 v252, 16, v210
    v_and_b32 v253, s33, v210
    v_pk_fma_f32 v[36:37], v[252:253], v[4:5], v[36:37] op_sel_hi:[1,0,1]
    v_lshlrev_b32 v254, 16, v211
    v_and_b32 v255, s33, v211
    v_pk_fma_f32 v[38:39], v[254:255], v[4:5], v[38:39] op_sel_hi:[1,0,1]
    v_lshlrev_b32 v252, 16, v212
    v_and_b32 v253, s33, v212
    v_pk_fma_f32 v[40:41], v[252:253], v[4:5], v[40:41] op_sel_hi:[1,0,1]
    v_lshlrev_b32 v254, 16, v213
    v_and_b32 v255, s33, v213
    v_pk_fma_f32 v[42:43], v[254:255], v[4:5], v[42:43] op_sel_hi:[1,0,1]
    v_lshlrev_b32 v252, 16, v214
    v_and_b32 v253, s33, v214
    v_pk_fma_f32 v[44:45], v[252:253], v[4:5], v[44:45] op_sel_hi:[1,0,1]
    v_lshlrev_b32 v254, 16, v215
    v_and_b32 v255, s33, v215
    v_pk_fma_f32 v[46:47], v[254:255], v[4:5], v[46:47] op_sel_hi:[1,0,1]
    s_waitcnt vmcnt(21)
    v_dot2_f32_bf16 v2, v216, v12, 0
    v_dot2_f32_bf16 v3, v217, v13, 0
    v_dot2_f32_bf16 v2, v218, v14, v2
    v_dot2_f32_bf16 v3, v219, v15, v3
    v_dot2_f32_bf16 v2, v220, v16, v2
    v_dot2_f32_bf16 v3, v221, v17, v3
    v_dot2_f32_bf16 v2, v222, v18, v2
    v_dot2_f32_bf16 v3, v223, v19, v3
    v_dot2_f32_bf16 v2, v224, v20, v2
    v_dot2_f32_bf16 v3, v225, v21, v3
    v_dot2_f32_bf16 v2, v226, v22, v2
    v_dot2_f32_bf16 v3, v227, v23, v3
    s_nop 2
    v_add_f32 v2, v2, v3
    s_nop 1
    v_add_f32_dpp v2, v2, v2 quad_perm:[1,0,3,2] row_mask:0xf bank_mask:0xf
    s_nop 1
    v_add_f32_dpp v2, v2, v2 quad_perm:[2,3,0,1] row_mask:0xf bank_mask:0xf
    s_nop 1
    v_add_f32_dpp v2, v2, v2 row_half_mirror row_mask:0xf bank_mask:0xf
    v_cmp_gt_f32 vcc, v2, v7
    s_cbranch_vccz L_nr8
    v_max_f32 v3, v2, v7
    s_nop 1
    v_max_f32_dpp v3, v3, v3 row_ror:8 row_mask:0xf bank_mask:0xf
    v_mov_b32 v5, v3
    s_nop 1
    v_permlane16_swap_b32 v5, v3
    v_max_f32 v3, v3, v5
    v_mov_b32 v5, v3
    s_nop 1
    v_permlane32_swap_b32 v5, v3
    v_max_f32 v3, v3, v5
    v_sub_f32 v5, v7, v3
    v_mul_f32 v5, s34, v5
    v_exp_f32 v4, v5
    v_mov_b32 v7, v3
    v_mul_f32 v8, s34, v3
    v_mul_f32 v9, v9, v4
    v_pk_mul_f32 v[24:25], v[24:25], v[4:5] op_sel_hi:[1,0]
    v_pk_mul_f32 v[26:27], v[26:27], v[4:5] op_sel_hi:[1,0]
    v_pk_mul_f32 v[28:29], v[28:29], v[4:5] op_sel_hi:[1,0]
    v_pk_mul_f32 v[30:31], v[30:31], v[4:5] op_sel_hi:[1,0]
    v_pk_mul_f32 v[32:33], v[32:33], v[4:5] op_sel_hi:[1,0]
    v_pk_mul_f32 v[34:35], v[34:35], v[4:5] op_sel_hi:[1,0]
    v_pk_mul_f32 v[36:37], v[36:37], v[4:5] op_sel_hi:[1,0]
    v_pk_mul_f32 v[38:39], v[38:39], v[4:5] op_sel_hi:[1,0]
    v_pk_mul_f32 v[40:41], v[40:41], v[4:5] op_sel_hi:[1,0]
    v_pk_mul_f32 v[42:43], v[42:43], v[4:5] op_sel_hi:[1,0]
    v_pk_mul_f32 v[44:45], v[44:45], v[4:5] op_sel_hi:[1,0]
    v_pk_mul_f32 v[46:47], v[46:47], v[4:5] op_sel_hi:[1,0]
L_nr8:
    v_fma_f32 v4, v2, s34, -v8
    v_exp_f32 v4, v4
    s_waitcnt vmcnt(18)
    v_add_f32 v9, v9, v4
    v_lshlrev_b32 v252, 16, v228
    v_and_b32 v253, s33, v228
    v_pk_fma_f32 v[24:25], v[252:253], v[4:5], v[24:25] op_sel_hi:[1,0,1]
    v_lshlrev_b32 v254, 16, v229
    v_and_b32 v255, s33, v229
    v_pk_fma_f32 v[26:27], v[254:255], v[4:5], v[26:27] op_sel_hi:[1,0,1]
    v_lshlrev_b32 v252, 16, v230
    v_and_b32 v253, s33, v230
    v_pk_fma_f32 v[28:29], v[252:253], v[4:5], v[28:29] op_sel_hi:[1,0,1]
    v_lshlrev_b32 v254, 16, v231
    v_and_b32 v255, s33, v231
    v_pk_fma_f32 v[30:31], v[254:255], v[4:5], v[30:31] op_sel_hi:[1,0,1]
    v_lshlrev_b32 v252, 16, v232
    v_and_b32 v253, s33, v232
    v_pk_fma_f32 v[32:33], v[252:253], v[4:5], v[32:33] op_sel_hi:[1,0,1]
    v_lshlrev_b32 v254, 16, v233
    v_and_b32 v255, s33, v233
    v_pk_fma_f32 v[34:35], v[254:255], v[4:5], v[34:35] op_sel_hi:[1,0,1]
    v_lshlrev_b32 v252, 16, v234
    v_and_b32 v253, s33, v234
    v_pk_fma_f32 v[36:37], v[252:253], v[4:5], v[36:37] op_sel_hi:[1,0,1]
    v_lshlrev_b32 v254, 16, v235
    v_and_b32 v255, s33, v235
    v_pk_fma_f32 v[38:39], v[254:255], v[4:5], v[38:39] op_sel_hi:[1,0,1]
    v_lshlrev_b32 v252, 16, v236
    v_and_b32 v253, s33, v236
    v_pk_fma_f32 v[40:41], v[252:253], v[4:5], v[40:41] op_sel_hi:[1,0,1]
    v_lshlrev_b32 v254, 16, v237
    v_and_b32 v255, s33, v237
    v_pk_fma_f32 v[42:43], v[254:255], v[4:5], v[42:43] op_sel_hi:[1,0,1]
    v_lshlrev_b32 v252, 16, v238
    v_and_b32 v253, s33, v238
    v_pk_fma_f32 v[44:45], v[252:253], v[4:5], v[44:45] op_sel_hi:[1,0,1]
    v_lshlrev_b32 v254, 16, v239
    v_and_b32 v255, s33, v239
    v_pk_fma_f32 v[46:47], v[254:255], v[4:5], v[46:47] op_sel_hi:[1,0,1]
    s_branch L_loop
L_sp0:
    s_and_b32 s23, s23, 0x7fc
    s_lshl_b32 s23, s23, 4
    v_lshl_add_u32 v238, v242, 3, s23
    s_cmp_eq_u32 s25, 2
    s_cbranch_scc1 L_sv0
    s_waitcnt vmcnt(15)
    v_dot2_f32_bf16 v252, v48, v12, 0
    v_dot2_f32_bf16 v254, v49, v13, 0
    v_dot2_f32_bf16 v252, v50, v14, v252
    v_dot2_f32_bf16 v254, v51, v15, v254
    v_dot2_f32_bf16 v252, v52, v16, v252
    v_dot2_f32_bf16 v254, v53, v17, v254
    v_dot2_f32_bf16 v252, v54, v18, v252
    v_dot2_f32_bf16 v254, v55, v19, v254
    v_dot2_f32_bf16 v252, v56, v20, v252
    v_dot2_f32_bf16 v254, v57, v21, v254
    v_dot2_f32_bf16 v252, v58, v22, v252
    v_dot2_f32_bf16 v254, v59, v23, v254
    buffer_load_dwordx4 v[48:51], v1, s[8:11], s28 offen offset:0 nt
    buffer_load_dwordx4 v[52:55], v1, s[8:11], s28 offen offset:128 nt
    buffer_load_dwordx4 v[56:59], v1, s[8:11], s28 offen offset:256 nt
    v_add_f32 v252, v252, v254
    s_nop 1
    v_add_f32_dpp v252, v252, v252 quad_perm:[1,0,3,2] row_mask:0xf bank_mask:0xf
    s_nop 1
    v_add_f32_dpp v252, v252, v252 quad_perm:[2,3,0,1] row_mask:0xf bank_mask:0xf
    s_nop 1
    v_add_f32_dpp v252, v252, v252 row_half_mirror row_mask:0xf bank_mask:0xf
    s_waitcnt vmcnt(15)
    v_dot2_f32_bf16 v253, v60, v12, 0
    v_dot2_f32_bf16 v255, v61, v13, 0
    v_dot2_f32_bf16 v253, v62, v14, v253
    v_dot2_f32_bf16 v255, v63, v15, v255
    v_dot2_f32_bf16 v253, v64, v16, v253
    v_dot2_f32_bf16 v255, v65, v17, v255
    v_dot2_f32_bf16 v253, v66, v18, v253
    v_dot2_f32_bf16 v255, v67, v19, v255
    v_dot2_f32_bf16 v253, v68, v20, v253
    v_dot2_f32_bf16 v255, v69, v21, v255
    v_dot2_f32_bf16 v253, v70, v22, v253
    v_dot2_f32_bf16 v255, v71, v23, v255
    buffer_load_dwordx4 v[60:63], v1, s[12:15], s24 offen offset:0 nt
    buffer_load_dwordx4 v[64:67], v1, s[12:15], s24 offen offset:128 nt
    buffer_load_dwordx4 v[68:71], v1, s[12:15], s24 offen offset:256 nt
    v_add_f32 v253, v253, v255
    s_nop 1
    v_add_f32_dpp v253, v253, v253 quad_perm:[1,0,3,2] row_mask:0xf bank_mask:0xf
    s_nop 1
    v_add_f32_dpp v253, v253, v253 quad_perm:[2,3,0,1] row_mask:0xf bank_mask:0xf
    s_nop 1
    v_add_f32_dpp v253, v253, v253 row_half_mirror row_mask:0xf bank_mask:0xf
    v_min_u32 v252, -2, v252
    v_min_u32 v253, -2, v253
    ds_write_b64 v238, v[252:253] offset:16896
    s_branch L_se0
L_sv0:
    ds_read_b64 v[236:237], v238 offset:16896
    s_waitcnt lgkmcnt(0)
    v_max_u32 v2, v236, v237
    v_cmp_eq_u32 vcc, -1, v2
    s_cbranch_vccnz L_sv0
    v_mov_b32 v2, v236
    v_cmp_gt_f32 vcc, v2, v7
    s_cbranch_vccz L_nr9
    v_max_f32 v3, v2, v7
    s_nop 1
    v_max_f32_dpp v3, v3, v3 row_ror:8 row_mask:0xf bank_mask:0xf
    v_mov_b32 v5, v3
    s_nop 1
    v_permlane16_swap_b32 v5, v3
    v_max_f32 v3, v3, v5
    v_mov_b32 v5, v3
    s_nop 1
    v_permlane32_swap_b32 v5, v3
    v_max_f32 v3, v3, v5
    v_sub_f32 v5, v7, v3
    v_mul_f32 v5, s34, v5
    v_exp_f32 v4, v5
    v_mov_b32 v7, v3
    v_mul_f32 v8, s34, v3
    v_mul_f32 v9, v9, v4
    v_pk_mul_f32 v[24:25], v[24:25], v[4:5] op_sel_hi:[1,0]
    v_pk_mul_f32 v[26:27], v[26:27], v[4:5] op_sel_hi:[1,0]
    v_pk_mul_f32 v[28:29], v[28:29], v[4:5] op_sel_hi:[1,0]
    v_pk_mul_f32 v[30:31], v[30:31], v[4:5] op_sel_hi:[1,0]
    v_pk_mul_f32 v[32:33], v[32:33], v[4:5] op_sel_hi:[1,0]
    v_pk_mul_f32 v[34:35], v[34:35], v[4:5] op_sel_hi:[1,0]
    v_pk_mul_f32 v[36:37], v[36:37], v[4:5] op_sel_hi:[1,0]
    v_pk_mul_f32 v[38:39], v[38:39], v[4:5] op_sel_hi:[1,0]
    v_pk_mul_f32 v[40:41], v[40:41], v[4:5] op_sel_hi:[1,0]
    v_pk_mul_f32 v[42:43], v[42:43], v[4:5] op_sel_hi:[1,0]
    v_pk_mul_f32 v[44:45], v[44:45], v[4:5] op_sel_hi:[1,0]
    v_pk_mul_f32 v[46:47], v[46:47], v[4:5] op_sel_hi:[1,0]
L_nr9:
    v_fma_f32 v4, v2, s34, -v8
    v_exp_f32 v4, v4
    s_waitcnt vmcnt(15)
    v_add_f32 v9, v9, v4
    v_lshlrev_b32 v252, 16, v48
    v_and_b32 v253, s33, v48
    v_pk_fma_f32 v[24:25], v[252:253], v[4:5], v[24:25] op_sel_hi:[1,0,1]
    v_lshlrev_b32 v254, 16, v49
    v_and_b32 v255, s33, v49
    v_pk_fma_f32 v[26:27], v[254:255], v[4:5], v[26:27] op_sel_hi:[1,0,1]
    v_lshlrev_b32 v252, 16, v50
    v_and_b32 v253, s33, v50
    v_pk_fma_f32 v[28:29], v[252:253], v[4:5], v[28:29] op_sel_hi:[1,0,1]
    v_lshlrev_b32 v254, 16, v51
    v_and_b32 v255, s33, v51
    v_pk_fma_f32 v[30:31], v[254:255], v[4:5], v[30:31] op_sel_hi:[1,0,1]
    v_lshlrev_b32 v252, 16, v52
    v_and_b32 v253, s33, v52
    v_pk_fma_f32 v[32:33], v[252:253], v[4:5], v[32:33] op_sel_hi:[1,0,1]
    v_lshlrev_b32 v254, 16, v53
    v_and_b32 v255, s33, v53
    v_pk_fma_f32 v[34:35], v[254:255], v[4:5], v[34:35] op_sel_hi:[1,0,1]
    v_lshlrev_b32 v252, 16, v54
    v_and_b32 v253, s33, v54
    v_pk_fma_f32 v[36:37], v[252:253], v[4:5], v[36:37] op_sel_hi:[1,0,1]
    v_lshlrev_b32 v254, 16, v55
    v_and_b32 v255, s33, v55
    v_pk_fma_f32 v[38:39], v[254:255], v[4:5], v[38:39] op_sel_hi:[1,0,1]
    v_lshlrev_b32 v252, 16, v56
    v_and_b32 v253, s33, v56
    v_pk_fma_f32 v[40:41], v[252:253], v[4:5], v[40:41] op_sel_hi:[1,0,1]
    v_lshlrev_b32 v254, 16, v57
    v_and_b32 v255, s33, v57
    v_pk_fma_f32 v[42:43], v[254:255], v[4:5], v[42:43] op_sel_hi:[1,0,1]
    v_lshlrev_b32 v252, 16, v58
    v_and_b32 v253, s33, v58
    v_pk_fma_f32 v[44:45], v[252:253], v[4:5], v[44:45] op_sel_hi:[1,0,1]
    v_lshlrev_b32 v254, 16, v59
    v_and_b32 v255, s33, v59
    v_pk_fma_f32 v[46:47], v[254:255], v[4:5], v[46:47] op_sel_hi:[1,0,1]
    buffer_load_dwordx4 v[48:51], v1, s[8:11], s28 offen offset:0 nt
    buffer_load_dwordx4 v[52:55], v1, s[8:11], s28 offen offset:128 nt
    buffer_load_dwordx4 v[56:59], v1, s[8:11], s28 offen offset:256 nt
    v_mov_b32 v2, v237
    v_cmp_gt_f32 vcc, v2, v7
    s_cbranch_vccz L_nr10
    v_max_f32 v3, v2, v7
    s_nop 1
    v_max_f32_dpp v3, v3, v3 row_ror:8 row_mask:0xf bank_mask:0xf
    v_mov_b32 v5, v3
    s_nop 1
    v_permlane16_swap_b32 v5, v3
    v_max_f32 v3, v3, v5
    v_mov_b32 v5, v3
    s_nop 1
    v_permlane32_swap_b32 v5, v3
    v_max_f32 v3, v3, v5
    v_sub_f32 v5, v7, v3
    v_mul_f32 v5, s34, v5
    v_exp_f32 v4, v5
    v_mov_b32 v7, v3
    v_mul_f32 v8, s34, v3
    v_mul_f32 v9, v9, v4
    v_pk_mul_f32 v[24:25], v[24:25], v[4:5] op_sel_hi:[1,0]
    v_pk_mul_f32 v[26:27], v[26:27], v[4:5] op_sel_hi:[1,0]
    v_pk_mul_f32 v[28:29], v[28:29], v[4:5] op_sel_hi:[1,0]
    v_pk_mul_f32 v[30:31], v[30:31], v[4:5] op_sel_hi:[1,0]
    v_pk_mul_f32 v[32:33], v[32:33], v[4:5] op_sel_hi:[1,0]
    v_pk_mul_f32 v[34:35], v[34:35], v[4:5] op_sel_hi:[1,0]
    v_pk_mul_f32 v[36:37], v[36:37], v[4:5] op_sel_hi:[1,0]
    v_pk_mul_f32 v[38:39], v[38:39], v[4:5] op_sel_hi:[1,0]
    v_pk_mul_f32 v[40:41], v[40:41], v[4:5] op_sel_hi:[1,0]
    v_pk_mul_f32 v[42:43], v[42:43], v[4:5] op_sel_hi:[1,0]
    v_pk_mul_f32 v[44:45], v[44:45], v[4:5] op_sel_hi:[1,0]
    v_pk_mul_f32 v[46:47], v[46:47], v[4:5] op_sel_hi:[1,0]
L_nr10:
    v_fma_f32 v4, v2, s34, -v8
    v_exp_f32 v4, v4
    s_waitcnt vmcnt(15)
    v_add_f32 v9, v9, v4
    v_lshlrev_b32 v252, 16, v60
    v_and_b32 v253, s33, v60
    v_pk_fma_f32 v[24:25], v[252:253], v[4:5], v[24:25] op_sel_hi:[1,0,1]
    v_lshlrev_b32 v254, 16, v61
    v_and_b32 v255, s33, v61
    v_pk_fma_f32 v[26:27], v[254:255], v[4:5], v[26:27] op_sel_hi:[1,0,1]
    v_lshlrev_b32 v252, 16, v62
    v_and_b32 v253, s33, v62
    v_pk_fma_f32 v[28:29], v[252:253], v[4:5], v[28:29] op_sel_hi:[1,0,1]
    v_lshlrev_b32 v254, 16, v63
    v_and_b32 v255, s33, v63
    v_pk_fma_f32 v[30:31], v[254:255], v[4:5], v[30:31] op_sel_hi:[1,0,1]
    v_lshlrev_b32 v252, 16, v64
    v_and_b32 v253, s33, v64
    v_pk_fma_f32 v[32:33], v[252:253], v[4:5], v[32:33] op_sel_hi:[1,0,1]
    v_lshlrev_b32 v254, 16, v65
    v_and_b32 v255, s33, v65
    v_pk_fma_f32 v[34:35], v[254:255], v[4:5], v[34:35] op_sel_hi:[1,0,1]
    v_lshlrev_b32 v252, 16, v66
    v_and_b32 v253, s33, v66
    v_pk_fma_f32 v[36:37], v[252:253], v[4:5], v[36:37] op_sel_hi:[1,0,1]
    v_lshlrev_b32 v254, 16, v67
    v_and_b32 v255, s33, v67
    v_pk_fma_f32 v[38:39], v[254:255], v[4:5], v[38:39] op_sel_hi:[1,0,1]
    v_lshlrev_b32 v252, 16, v68
    v_and_b32 v253, s33, v68
    v_pk_fma_f32 v[40:41], v[252:253], v[4:5], v[40:41] op_sel_hi:[1,0,1]
    v_lshlrev_b32 v254, 16, v69
    v_and_b32 v255, s33, v69
    v_pk_fma_f32 v[42:43], v[254:255], v[4:5], v[42:43] op_sel_hi:[1,0,1]
    v_lshlrev_b32 v252, 16, v70
    v_and_b32 v253, s33, v70
    v_pk_fma_f32 v[44:45], v[252:253], v[4:5], v[44:45] op_sel_hi:[1,0,1]
    v_lshlrev_b32 v254, 16, v71
    v_and_b32 v255, s33, v71
    v_pk_fma_f32 v[46:47], v[254:255], v[4:5], v[46:47] op_sel_hi:[1,0,1]
    buffer_load_dwordx4 v[60:63], v1, s[12:15], s24 offen offset:0 nt
    buffer_load_dwordx4 v[64:67], v1, s[12:15], s24 offen offset:128 nt
    buffer_load_dwordx4 v[68:71], v1, s[12:15], s24 offen offset:256 nt
    s_branch L_se0
L_sp1:
    s_and_b32 s23, s23, 0x7fc
    s_lshl_b32 s23, s23, 4
    v_lshl_add_u32 v238, v242, 3, s23
    s_cmp_eq_u32 s25, 2
    s_cbranch_scc1 L_sv1
    s_waitcnt vmcnt(15)
    v_dot2_f32_bf16 v252, v72, v12, 0
    v_dot2_f32_bf16 v254, v73, v13, 0
    v_dot2_f32_bf16 v252, v74, v14, v252
    v_dot2_f32_bf16 v254, v75, v15, v254
    v_dot2_f32_bf16 v252, v76, v16, v252
    v_dot2_f32_bf16 v254, v77, v17, v254
    v_dot2_f32_bf16 v252, v78, v18, v252
    v_dot2_f32_bf16 v254, v79, v19, v254
    v_dot2_f32_bf16 v252, v80, v20, v252
    v_dot2_f32_bf16 v254, v81, v21, v254
    v_dot2_f32_bf16 v252, v82, v22, v252
    v_dot2_f32_bf16 v254, v83, v23, v254
    buffer_load_dwordx4 v[72:75], v1, s[8:11], s28 offen offset:0 nt
    buffer_load_dwordx4 v[76:79], v1, s[8:11], s28 offen offset:128 nt
    buffer_load_dwordx4 v[80:83], v1, s[8:11], s28 offen offset:256 nt
    v_add_f32 v252, v252, v254
    s_nop 1
    v_add_f32_dpp v252, v252, v252 quad_perm:[1,0,3,2] row_mask:0xf bank_mask:0xf
    s_nop 1
    v_add_f32_dpp v252, v252, v252 quad_perm:[2,3,0,1] row_mask:0xf bank_mask:0xf
    s_nop 1
    v_add_f32_dpp v252, v252, v252 row_half_mirror row_mask:0xf bank_mask:0xf
    s_waitcnt vmcnt(15)
    v_dot2_f32_bf16 v253, v84, v12, 0
    v_dot2_f32_bf16 v255, v85, v13, 0
    v_dot2_f32_bf16 v253, v86, v14, v253
    v_dot2_f32_bf16 v255, v87, v15, v255
    v_dot2_f32_bf16 v253, v88, v16, v253
    v_dot2_f32_bf16 v255, v89, v17, v255
    v_dot2_f32_bf16 v253, v90, v18, v253
    v_dot2_f32_bf16 v255, v91, v19, v255
    v_dot2_f32_bf16 v253, v92, v20, v253
    v_dot2_f32_bf16 v255, v93, v21, v255
    v_dot2_f32_bf16 v253, v94, v22, v253
    v_dot2_f32_bf16 v255, v95, v23, v255
    buffer_load_dwordx4 v[84:87], v1, s[12:15], s24 offen offset:0 nt
    buffer_load_dwordx4 v[88:91], v1, s[12:15], s24 offen offset:128 nt
    buffer_load_dwordx4 v[92:95], v1, s[12:15], s24 offen offset:256 nt
    v_add_f32 v253, v253, v255
    s_nop 1
    v_add_f32_dpp v253, v253, v253 quad_perm:[1,0,3,2] row_mask:0xf bank_mask:0xf
    s_nop 1
    v_add_f32_dpp v253, v253, v253 quad_perm:[2,3,0,1] row_mask:0xf bank_mask:0xf
    s_nop 1
    v_add_f32_dpp v253, v253, v253 row_half_mirror row_mask:0xf bank_mask:0xf
    v_min_u32 v252, -2, v252
    v_min_u32 v253, -2, v253
    ds_write_b64 v238, v[252:253] offset:16896
    s_branch L_se1
L_sv1:
    ds_read_b64 v[236:237], v238 offset:16896
    s_waitcnt lgkmcnt(0)
    v_max_u32 v2, v236, v237
    v_cmp_eq_u32 vcc, -1, v2
    s_cbranch_vccnz L_sv1
    v_mov_b32 v2, v236
    v_cmp_gt_f32 vcc, v2, v7
    s_cbranch_vccz L_nr11
    v_max_f32 v3, v2, v7
    s_nop 1
    v_max_f32_dpp v3, v3, v3 row_ror:8 row_mask:0xf bank_mask:0xf
    v_mov_b32 v5, v3
    s_nop 1
    v_permlane16_swap_b32 v5, v3
    v_max_f32 v3, v3, v5
    v_mov_b32 v5, v3
    s_nop 1
    v_permlane32_swap_b32 v5, v3
    v_max_f32 v3, v3, v5
    v_sub_f32 v5, v7, v3
    v_mul_f32 v5, s34, v5
    v_exp_f32 v4, v5
    v_mov_b32 v7, v3
    v_mul_f32 v8, s34, v3
    v_mul_f32 v9, v9, v4
    v_pk_mul_f32 v[24:25], v[24:25], v[4:5] op_sel_hi:[1,0]
    v_pk_mul_f32 v[26:27], v[26:27], v[4:5] op_sel_hi:[1,0]
    v_pk_mul_f32 v[28:29], v[28:29], v[4:5] op_sel_hi:[1,0]
    v_pk_mul_f32 v[30:31], v[30:31], v[4:5] op_sel_hi:[1,0]
    v_pk_mul_f32 v[32:33], v[32:33], v[4:5] op_sel_hi:[1,0]
    v_pk_mul_f32 v[34:35], v[34:35], v[4:5] op_sel_hi:[1,0]
    v_pk_mul_f32 v[36:37], v[36:37], v[4:5] op_sel_hi:[1,0]
    v_pk_mul_f32 v[38:39], v[38:39], v[4:5] op_sel_hi:[1,0]
    v_pk_mul_f32 v[40:41], v[40:41], v[4:5] op_sel_hi:[1,0]
    v_pk_mul_f32 v[42:43], v[42:43], v[4:5] op_sel_hi:[1,0]
    v_pk_mul_f32 v[44:45], v[44:45], v[4:5] op_sel_hi:[1,0]
    v_pk_mul_f32 v[46:47], v[46:47], v[4:5] op_sel_hi:[1,0]
L_nr11:
    v_fma_f32 v4, v2, s34, -v8
    v_exp_f32 v4, v4
    s_waitcnt vmcnt(15)
    v_add_f32 v9, v9, v4
    v_lshlrev_b32 v252, 16, v72
    v_and_b32 v253, s33, v72
    v_pk_fma_f32 v[24:25], v[252:253], v[4:5], v[24:25] op_sel_hi:[1,0,1]
    v_lshlrev_b32 v254, 16, v73
    v_and_b32 v255, s33, v73
    v_pk_fma_f32 v[26:27], v[254:255], v[4:5], v[26:27] op_sel_hi:[1,0,1]
    v_lshlrev_b32 v252, 16, v74
    v_and_b32 v253, s33, v74
    v_pk_fma_f32 v[28:29], v[252:253], v[4:5], v[28:29] op_sel_hi:[1,0,1]
    v_lshlrev_b32 v254, 16, v75
    v_and_b32 v255, s33, v75
    v_pk_fma_f32 v[30:31], v[254:255], v[4:5], v[30:31] op_sel_hi:[1,0,1]
    v_lshlrev_b32 v252, 16, v76
    v_and_b32 v253, s33, v76
    v_pk_fma_f32 v[32:33], v[252:253], v[4:5], v[32:33] op_sel_hi:[1,0,1]
    v_lshlrev_b32 v254, 16, v77
    v_and_b32 v255, s33, v77
    v_pk_fma_f32 v[34:35], v[254:255], v[4:5], v[34:35] op_sel_hi:[1,0,1]
    v_lshlrev_b32 v252, 16, v78
    v_and_b32 v253, s33, v78
    v_pk_fma_f32 v[36:37], v[252:253], v[4:5], v[36:37] op_sel_hi:[1,0,1]
    v_lshlrev_b32 v254, 16, v79
    v_and_b32 v255, s33, v79
    v_pk_fma_f32 v[38:39], v[254:255], v[4:5], v[38:39] op_sel_hi:[1,0,1]
    v_lshlrev_b32 v252, 16, v80
    v_and_b32 v253, s33, v80
    v_pk_fma_f32 v[40:41], v[252:253], v[4:5], v[40:41] op_sel_hi:[1,0,1]
    v_lshlrev_b32 v254, 16, v81
    v_and_b32 v255, s33, v81
    v_pk_fma_f32 v[42:43], v[254:255], v[4:5], v[42:43] op_sel_hi:[1,0,1]
    v_lshlrev_b32 v252, 16, v82
    v_and_b32 v253, s33, v82
    v_pk_fma_f32 v[44:45], v[252:253], v[4:5], v[44:45] op_sel_hi:[1,0,1]
    v_lshlrev_b32 v254, 16, v83
    v_and_b32 v255, s33, v83
    v_pk_fma_f32 v[46:47], v[254:255], v[4:5], v[46:47] op_sel_hi:[1,0,1]
    buffer_load_dwordx4 v[72:75], v1, s[8:11], s28 offen offset:0 nt
    buffer_load_dwordx4 v[76:79], v1, s[8:11], s28 offen offset:128 nt
    buffer_load_dwordx4 v[80:83], v1, s[8:11], s28 offen offset:256 nt
    v_mov_b32 v2, v237
    v_cmp_gt_f32 vcc, v2, v7
    s_cbranch_vccz L_nr12
    v_max_f32 v3, v2, v7
    s_nop 1
    v_max_f32_dpp v3, v3, v3 row_ror:8 row_mask:0xf bank_mask:0xf
    v_mov_b32 v5, v3
    s_nop 1
    v_permlane16_swap_b32 v5, v3
    v_max_f32 v3, v3, v5
    v_mov_b32 v5, v3
    s_nop 1
    v_permlane32_swap_b32 v5, v3
    v_max_f32 v3, v3, v5
    v_sub_f32 v5, v7, v3
    v_mul_f32 v5, s34, v5
    v_exp_f32 v4, v5
    v_mov_b32 v7, v3
    v_mul_f32 v8, s34, v3
    v_mul_f32 v9, v9, v4
    v_pk_mul_f32 v[24:25], v[24:25], v[4:5] op_sel_hi:[1,0]
    v_pk_mul_f32 v[26:27], v[26:27], v[4:5] op_sel_hi:[1,0]
    v_pk_mul_f32 v[28:29], v[28:29], v[4:5] op_sel_hi:[1,0]
    v_pk_mul_f32 v[30:31], v[30:31], v[4:5] op_sel_hi:[1,0]
    v_pk_mul_f32 v[32:33], v[32:33], v[4:5] op_sel_hi:[1,0]
    v_pk_mul_f32 v[34:35], v[34:35], v[4:5] op_sel_hi:[1,0]
    v_pk_mul_f32 v[36:37], v[36:37], v[4:5] op_sel_hi:[1,0]
    v_pk_mul_f32 v[38:39], v[38:39], v[4:5] op_sel_hi:[1,0]
    v_pk_mul_f32 v[40:41], v[40:41], v[4:5] op_sel_hi:[1,0]
    v_pk_mul_f32 v[42:43], v[42:43], v[4:5] op_sel_hi:[1,0]
    v_pk_mul_f32 v[44:45], v[44:45], v[4:5] op_sel_hi:[1,0]
    v_pk_mul_f32 v[46:47], v[46:47], v[4:5] op_sel_hi:[1,0]
L_nr12:
    v_fma_f32 v4, v2, s34, -v8
    v_exp_f32 v4, v4
    s_waitcnt vmcnt(15)
    v_add_f32 v9, v9, v4
    v_lshlrev_b32 v252, 16, v84
    v_and_b32 v253, s33, v84
    v_pk_fma_f32 v[24:25], v[252:253], v[4:5], v[24:25] op_sel_hi:[1,0,1]
    v_lshlrev_b32 v254, 16, v85
    v_and_b32 v255, s33, v85
    v_pk_fma_f32 v[26:27], v[254:255], v[4:5], v[26:27] op_sel_hi:[1,0,1]
    v_lshlrev_b32 v252, 16, v86
    v_and_b32 v253, s33, v86
    v_pk_fma_f32 v[28:29], v[252:253], v[4:5], v[28:29] op_sel_hi:[1,0,1]
    v_lshlrev_b32 v254, 16, v87
    v_and_b32 v255, s33, v87
    v_pk_fma_f32 v[30:31], v[254:255], v[4:5], v[30:31] op_sel_hi:[1,0,1]
    v_lshlrev_b32 v252, 16, v88
    v_and_b32 v253, s33, v88
    v_pk_fma_f32 v[32:33], v[252:253], v[4:5], v[32:33] op_sel_hi:[1,0,1]
    v_lshlrev_b32 v254, 16, v89
    v_and_b32 v255, s33, v89
    v_pk_fma_f32 v[34:35], v[254:255], v[4:5], v[34:35] op_sel_hi:[1,0,1]
    v_lshlrev_b32 v252, 16, v90
    v_and_b32 v253, s33, v90
    v_pk_fma_f32 v[36:37], v[252:253], v[4:5], v[36:37] op_sel_hi:[1,0,1]
    v_lshlrev_b32 v254, 16, v91
    v_and_b32 v255, s33, v91
    v_pk_fma_f32 v[38:39], v[254:255], v[4:5], v[38:39] op_sel_hi:[1,0,1]
    v_lshlrev_b32 v252, 16, v92
    v_and_b32 v253, s33, v92
    v_pk_fma_f32 v[40:41], v[252:253], v[4:5], v[40:41] op_sel_hi:[1,0,1]
    v_lshlrev_b32 v254, 16, v93
    v_and_b32 v255, s33, v93
    v_pk_fma_f32 v[42:43], v[254:255], v[4:5], v[42:43] op_sel_hi:[1,0,1]
    v_lshlrev_b32 v252, 16, v94
    v_and_b32 v253, s33, v94
    v_pk_fma_f32 v[44:45], v[252:253], v[4:5], v[44:45] op_sel_hi:[1,0,1]
    v_lshlrev_b32 v254, 16, v95
    v_and_b32 v255, s33, v95
    v_pk_fma_f32 v[46:47], v[254:255], v[4:5], v[46:47] op_sel_hi:[1,0,1]
    buffer_load_dwordx4 v[84:87], v1, s[12:15], s24 offen offset:0 nt
    buffer_load_dwordx4 v[88:91], v1, s[12:15], s24 offen offset:128 nt
    buffer_load_dwordx4 v[92:95], v1, s[12:15], s24 offen offset:256 nt
    s_branch L_se1
L_sp2:
    s_and_b32 s23, s23, 0x7fc
    s_lshl_b32 s23, s23, 4
    v_lshl_add_u32 v238, v242, 3, s23
    s_cmp_eq_u32 s25, 2
    s_cbranch_scc1 L_sv2
    s_waitcnt vmcnt(15)
    v_dot2_f32_bf16 v252, v96, v12, 0
    v_dot2_f32_bf16 v254, v97, v13, 0
    v_dot2_f32_bf16 v252, v98, v14, v252
    v_dot2_f32_bf16 v254, v99, v15, v254
    v_dot2_f32_bf16 v252, v100, v16, v252
    v_dot2_f32_bf16 v254, v101, v17, v254
    v_dot2_f32_bf16 v252, v102, v18, v252
    v_dot2_f32_bf16 v254, v103, v19, v254
    v_dot2_f32_bf16 v252, v104, v20, v252
    v_dot2_f32_bf16 v254, v105, v21, v254
    v_dot2_f32_bf16 v252, v106, v22, v252
    v_dot2_f32_bf16 v254, v107, v23, v254
    buffer_load_dwordx4 v[96:99], v1, s[8:11], s28 offen offset:0 nt
    buffer_load_dwordx4 v[100:103], v1, s[8:11], s28 offen offset:128 nt
    buffer_load_dwordx4 v[104:107], v1, s[8:11], s28 offen offset:256 nt
    v_add_f32 v252, v252, v254
    s_nop 1
    v_add_f32_dpp v252, v252, v252 quad_perm:[1,0,3,2] row_mask:0xf bank_mask:0xf
    s_nop 1
    v_add_f32_dpp v252, v252, v252 quad_perm:[2,3,0,1] row_mask:0xf bank_mask:0xf
    s_nop 1
    v_add_f32_dpp v252, v252, v252 row_half_mirror row_mask:0xf bank_mask:0xf
    s_waitcnt vmcnt(15)
    v_dot2_f32_bf16 v253, v108, v12, 0
    v_dot2_f32_bf16 v255, v109, v13, 0
    v_dot2_f32_bf16 v253, v110, v14, v253
    v_dot2_f32_bf16 v255, v111, v15, v255
    v_dot2_f32_bf16 v253, v112, v16, v253
    v_dot2_f32_bf16 v255, v113, v17, v255
    v_dot2_f32_bf16 v253, v114, v18, v253
    v_dot2_f32_bf16 v255, v115, v19, v255
    v_dot2_f32_bf16 v253, v116, v20, v253
    v_dot2_f32_bf16 v255, v117, v21, v255
    v_dot2_f32_bf16 v253, v118, v22, v253
    v_dot2_f32_bf16 v255, v119, v23, v255
    buffer_load_dwordx4 v[108:111], v1, s[12:15], s24 offen offset:0 nt
    buffer_load_dwordx4 v[112:115], v1, s[12:15], s24 offen offset:128 nt
    buffer_load_dwordx4 v[116:119], v1, s[12:15], s24 offen offset:256 nt
    v_add_f32 v253, v253, v255
    s_nop 1
    v_add_f32_dpp v253, v253, v253 quad_perm:[1,0,3,2] row_mask:0xf bank_mask:0xf
    s_nop 1
    v_add_f32_dpp v253, v253, v253 quad_perm:[2,3,0,1] row_mask:0xf bank_mask:0xf
    s_nop 1
    v_add_f32_dpp v253, v253, v253 row_half_mirror row_mask:0xf bank_mask:0xf
    v_min_u32 v252, -2, v252
    v_min_u32 v253, -2, v253
    ds_write_b64 v238, v[252:253] offset:16896
    s_branch L_se2
L_sv2:
    ds_read_b64 v[236:237], v238 offset:16896
    s_waitcnt lgkmcnt(0)
    v_max_u32 v2, v236, v237
    v_cmp_eq_u32 vcc, -1, v2
    s_cbranch_vccnz L_sv2
    v_mov_b32 v2, v236
    v_cmp_gt_f32 vcc, v2, v7
    s_cbranch_vccz L_nr13
    v_max_f32 v3, v2, v7
    s_nop 1
    v_max_f32_dpp v3, v3, v3 row_ror:8 row_mask:0xf bank_mask:0xf
    v_mov_b32 v5, v3
    s_nop 1
    v_permlane16_swap_b32 v5, v3
    v_max_f32 v3, v3, v5
    v_mov_b32 v5, v3
    s_nop 1
    v_permlane32_swap_b32 v5, v3
    v_max_f32 v3, v3, v5
    v_sub_f32 v5, v7, v3
    v_mul_f32 v5, s34, v5
    v_exp_f32 v4, v5
    v_mov_b32 v7, v3
    v_mul_f32 v8, s34, v3
    v_mul_f32 v9, v9, v4
    v_pk_mul_f32 v[24:25], v[24:25], v[4:5] op_sel_hi:[1,0]
    v_pk_mul_f32 v[26:27], v[26:27], v[4:5] op_sel_hi:[1,0]
    v_pk_mul_f32 v[28:29], v[28:29], v[4:5] op_sel_hi:[1,0]
    v_pk_mul_f32 v[30:31], v[30:31], v[4:5] op_sel_hi:[1,0]
    v_pk_mul_f32 v[32:33], v[32:33], v[4:5] op_sel_hi:[1,0]
    v_pk_mul_f32 v[34:35], v[34:35], v[4:5] op_sel_hi:[1,0]
    v_pk_mul_f32 v[36:37], v[36:37], v[4:5] op_sel_hi:[1,0]
    v_pk_mul_f32 v[38:39], v[38:39], v[4:5] op_sel_hi:[1,0]
    v_pk_mul_f32 v[40:41], v[40:41], v[4:5] op_sel_hi:[1,0]
    v_pk_mul_f32 v[42:43], v[42:43], v[4:5] op_sel_hi:[1,0]
    v_pk_mul_f32 v[44:45], v[44:45], v[4:5] op_sel_hi:[1,0]
    v_pk_mul_f32 v[46:47], v[46:47], v[4:5] op_sel_hi:[1,0]
L_nr13:
    v_fma_f32 v4, v2, s34, -v8
    v_exp_f32 v4, v4
    s_waitcnt vmcnt(15)
    v_add_f32 v9, v9, v4
    v_lshlrev_b32 v252, 16, v96
    v_and_b32 v253, s33, v96
    v_pk_fma_f32 v[24:25], v[252:253], v[4:5], v[24:25] op_sel_hi:[1,0,1]
    v_lshlrev_b32 v254, 16, v97
    v_and_b32 v255, s33, v97
    v_pk_fma_f32 v[26:27], v[254:255], v[4:5], v[26:27] op_sel_hi:[1,0,1]
    v_lshlrev_b32 v252, 16, v98
    v_and_b32 v253, s33, v98
    v_pk_fma_f32 v[28:29], v[252:253], v[4:5], v[28:29] op_sel_hi:[1,0,1]
    v_lshlrev_b32 v254, 16, v99
    v_and_b32 v255, s33, v99
    v_pk_fma_f32 v[30:31], v[254:255], v[4:5], v[30:31] op_sel_hi:[1,0,1]
    v_lshlrev_b32 v252, 16, v100
    v_and_b32 v253, s33, v100
    v_pk_fma_f32 v[32:33], v[252:253], v[4:5], v[32:33] op_sel_hi:[1,0,1]
    v_lshlrev_b32 v254, 16, v101
    v_and_b32 v255, s33, v101
    v_pk_fma_f32 v[34:35], v[254:255], v[4:5], v[34:35] op_sel_hi:[1,0,1]
    v_lshlrev_b32 v252, 16, v102
    v_and_b32 v253, s33, v102
    v_pk_fma_f32 v[36:37], v[252:253], v[4:5], v[36:37] op_sel_hi:[1,0,1]
    v_lshlrev_b32 v254, 16, v103
    v_and_b32 v255, s33, v103
    v_pk_fma_f32 v[38:39], v[254:255], v[4:5], v[38:39] op_sel_hi:[1,0,1]
    v_lshlrev_b32 v252, 16, v104
    v_and_b32 v253, s33, v104
    v_pk_fma_f32 v[40:41], v[252:253], v[4:5], v[40:41] op_sel_hi:[1,0,1]
    v_lshlrev_b32 v254, 16, v105
    v_and_b32 v255, s33, v105
    v_pk_fma_f32 v[42:43], v[254:255], v[4:5], v[42:43] op_sel_hi:[1,0,1]
    v_lshlrev_b32 v252, 16, v106
    v_and_b32 v253, s33, v106
    v_pk_fma_f32 v[44:45], v[252:253], v[4:5], v[44:45] op_sel_hi:[1,0,1]
    v_lshlrev_b32 v254, 16, v107
    v_and_b32 v255, s33, v107
    v_pk_fma_f32 v[46:47], v[254:255], v[4:5], v[46:47] op_sel_hi:[1,0,1]
    buffer_load_dwordx4 v[96:99], v1, s[8:11], s28 offen offset:0 nt
    buffer_load_dwordx4 v[100:103], v1, s[8:11], s28 offen offset:128 nt
    buffer_load_dwordx4 v[104:107], v1, s[8:11], s28 offen offset:256 nt
    v_mov_b32 v2, v237
    v_cmp_gt_f32 vcc, v2, v7
    s_cbranch_vccz L_nr14
    v_max_f32 v3, v2, v7
    s_nop 1
    v_max_f32_dpp v3, v3, v3 row_ror:8 row_mask:0xf bank_mask:0xf
    v_mov_b32 v5, v3
    s_nop 1
    v_permlane16_swap_b32 v5, v3
    v_max_f32 v3, v3, v5
    v_mov_b32 v5, v3
    s_nop 1
    v_permlane32_swap_b32 v5, v3
    v_max_f32 v3, v3, v5
    v_sub_f32 v5, v7, v3
    v_mul_f32 v5, s34, v5
    v_exp_f32 v4, v5
    v_mov_b32 v7, v3
    v_mul_f32 v8, s34, v3
    v_mul_f32 v9, v9, v4
    v_pk_mul_f32 v[24:25], v[24:25], v[4:5] op_sel_hi:[1,0]
    v_pk_mul_f32 v[26:27], v[26:27], v[4:5] op_sel_hi:[1,0]
    v_pk_mul_f32 v[28:29], v[28:29], v[4:5] op_sel_hi:[1,0]
    v_pk_mul_f32 v[30:31], v[30:31], v[4:5] op_sel_hi:[1,0]
    v_pk_mul_f32 v[32:33], v[32:33], v[4:5] op_sel_hi:[1,0]
    v_pk_mul_f32 v[34:35], v[34:35], v[4:5] op_sel_hi:[1,0]
    v_pk_mul_f32 v[36:37], v[36:37], v[4:5] op_sel_hi:[1,0]
    v_pk_mul_f32 v[38:39], v[38:39], v[4:5] op_sel_hi:[1,0]
    v_pk_mul_f32 v[40:41], v[40:41], v[4:5] op_sel_hi:[1,0]
    v_pk_mul_f32 v[42:43], v[42:43], v[4:5] op_sel_hi:[1,0]
    v_pk_mul_f32 v[44:45], v[44:45], v[4:5] op_sel_hi:[1,0]
    v_pk_mul_f32 v[46:47], v[46:47], v[4:5] op_sel_hi:[1,0]
L_nr14:
    v_fma_f32 v4, v2, s34, -v8
    v_exp_f32 v4, v4
    s_waitcnt vmcnt(15)
    v_add_f32 v9, v9, v4
    v_lshlrev_b32 v252, 16, v108
    v_and_b32 v253, s33, v108
    v_pk_fma_f32 v[24:25], v[252:253], v[4:5], v[24:25] op_sel_hi:[1,0,1]
    v_lshlrev_b32 v254, 16, v109
    v_and_b32 v255, s33, v109
    v_pk_fma_f32 v[26:27], v[254:255], v[4:5], v[26:27] op_sel_hi:[1,0,1]
    v_lshlrev_b32 v252, 16, v110
    v_and_b32 v253, s33, v110
    v_pk_fma_f32 v[28:29], v[252:253], v[4:5], v[28:29] op_sel_hi:[1,0,1]
    v_lshlrev_b32 v254, 16, v111
    v_and_b32 v255, s33, v111
    v_pk_fma_f32 v[30:31], v[254:255], v[4:5], v[30:31] op_sel_hi:[1,0,1]
    v_lshlrev_b32 v252, 16, v112
    v_and_b32 v253, s33, v112
    v_pk_fma_f32 v[32:33], v[252:253], v[4:5], v[32:33] op_sel_hi:[1,0,1]
    v_lshlrev_b32 v254, 16, v113
    v_and_b32 v255, s33, v113
    v_pk_fma_f32 v[34:35], v[254:255], v[4:5], v[34:35] op_sel_hi:[1,0,1]
    v_lshlrev_b32 v252, 16, v114
    v_and_b32 v253, s33, v114
    v_pk_fma_f32 v[36:37], v[252:253], v[4:5], v[36:37] op_sel_hi:[1,0,1]
    v_lshlrev_b32 v254, 16, v115
    v_and_b32 v255, s33, v115
    v_pk_fma_f32 v[38:39], v[254:255], v[4:5], v[38:39] op_sel_hi:[1,0,1]
    v_lshlrev_b32 v252, 16, v116
    v_and_b32 v253, s33, v116
    v_pk_fma_f32 v[40:41], v[252:253], v[4:5], v[40:41] op_sel_hi:[1,0,1]
    v_lshlrev_b32 v254, 16, v117
    v_and_b32 v255, s33, v117
    v_pk_fma_f32 v[42:43], v[254:255], v[4:5], v[42:43] op_sel_hi:[1,0,1]
    v_lshlrev_b32 v252, 16, v118
    v_and_b32 v253, s33, v118
    v_pk_fma_f32 v[44:45], v[252:253], v[4:5], v[44:45] op_sel_hi:[1,0,1]
    v_lshlrev_b32 v254, 16, v119
    v_and_b32 v255, s33, v119
    v_pk_fma_f32 v[46:47], v[254:255], v[4:5], v[46:47] op_sel_hi:[1,0,1]
    buffer_load_dwordx4 v[108:111], v1, s[12:15], s24 offen offset:0 nt
    buffer_load_dwordx4 v[112:115], v1, s[12:15], s24 offen offset:128 nt
    buffer_load_dwordx4 v[116:119], v1, s[12:15], s24 offen offset:256 nt
    s_branch L_se2
L_done:
    v_add_f32_dpp v9, v9, v9 row_ror:8 row_mask:0xf bank_mask:0xf
    v_permlane32_swap_b32 v24, v36
    v_permlane32_swap_b32 v25, v37
    v_permlane32_swap_b32 v26, v38
    v_permlane32_swap_b32 v27, v39
    v_permlane32_swap_b32 v28, v40
    v_permlane32_swap_b32 v29, v41
    v_permlane32_swap_b32 v30, v42
    v_permlane32_swap_b32 v31, v43
    v_permlane32_swap_b32 v32, v44
    v_permlane32_swap_b32 v33, v45
    v_permlane32_swap_b32 v34, v46
    v_permlane32_swap_b32 v35, v47
    v_mov_b32 v5, v9
    v_pk_add_f32 v[24:25], v[24:25], v[36:37]
    v_pk_add_f32 v[26:27], v[26:27], v[38:39]
    v_pk_add_f32 v[28:29], v[28:29], v[40:41]
    v_pk_add_f32 v[30:31], v[30:31], v[42:43]
    v_pk_add_f32 v[32:33], v[32:33], v[44:45]
    v_pk_add_f32 v[34:35], v[34:35], v[46:47]
    v_permlane32_swap_b32 v5, v9
    v_permlane16_swap_b32 v24, v30
    v_permlane16_swap_b32 v25, v31
    v_permlane16_swap_b32 v26, v32
    v_permlane16_swap_b32 v27, v33
    v_permlane16_swap_b32 v28, v34
    v_permlane16_swap_b32 v29, v35
    v_add_f32 v9, v9, v5
    v_pk_add_f32 v[24:25], v[24:25], v[30:31]
    v_pk_add_f32 v[26:27], v[26:27], v[32:33]
    v_pk_add_f32 v[28:29], v[28:29], v[34:35]
    v_mov_b32 v5, v9
    v_mov_b32 v30, v8
    v_add_f32_dpp v24, v24, v24 row_ror:8 row_mask:0xf bank_mask:0xf
    v_add_f32_dpp v25, v25, v25 row_ror:8 row_mask:0xf bank_mask:0xf
    v_add_f32_dpp v26, v26, v26 row_ror:8 row_mask:0xf bank_mask:0xf
    v_add_f32_dpp v27, v27, v27 row_ror:8 row_mask:0xf bank_mask:0xf
    v_permlane16_swap_b32 v5, v9
    ds_write_b128 v244, v[24:27] offset:512
    v_add_f32_dpp v28, v28, v28 row_ror:8 row_mask:0xf bank_mask:0xf
    v_add_f32_dpp v29, v29, v29 row_ror:8 row_mask:0xf bank_mask:0xf
    v_add_f32 v31, v9, v5
    ds_write_b128 v244, v[28:31] offset:1024
    s_cmp_lt_u32 s3, 4
    s_cbranch_scc1 L_help
    s_cmp_lg_u32 s3, 4
    s_waitcnt lgkmcnt(0)
    s_barrier
    s_cbranch_scc1 L_wait3
L_merge:
    ds_read_b128 v[124:127], v245 offset:1024
    ds_read_b128 v[132:135], v245 offset:2048
    ds_read_b128 v[140:143], v245 offset:3072
    ds_read_b128 v[148:151], v245 offset:4096
    ds_read_b128 v[120:123], v245 offset:512
    ds_read_b128 v[128:131], v245 offset:1536
    ds_read_b128 v[136:139], v245 offset:2560
    ds_read_b128 v[144:147], v245 offset:3584
    v_mov_b32 v153, s32
    v_mov_b32 v155, s32
    v_mov_b32 v157, s32
    v_mov_b32 v159, s32
    s_waitcnt lgkmcnt(4)
    v_max3_f32 v2, v126, v134, v142
    v_max_f32 v2, v2, v150
    v_max_f32 v3, v2, v150
    s_nop 1
    v_permlane32_swap_b32 v3, v2
    v_max_f32 v2, v2, v3
    v_sub_f32 v126, v126, v2
    v_sub_f32 v134, v134, v2
    v_sub_f32 v142, v142, v2
    v_sub_f32 v150, v150, v2
    v_exp_f32 v126, v126
    v_exp_f32 v134, v134
    v_exp_f32 v142, v142
    v_exp_f32 v150, v150
    v_pk_mul_f32 v[164:165], v[124:125], v[126:127] op_sel_hi:[1,0]
    v_pk_mul_f32 v[166:167], v[126:127], v[126:127] op_sel_hi:[1,0]
    v_pk_fma_f32 v[164:165], v[132:133], v[134:135], v[164:165] op_sel_hi:[1,0,1]
    v_pk_fma_f32 v[166:167], v[134:135], v[134:135], v[166:167] op_sel_hi:[1,0,1]
    v_pk_fma_f32 v[164:165], v[140:141], v[142:143], v[164:165] op_sel_hi:[1,0,1]
    v_pk_fma_f32 v[166:167], v[142:143], v[142:143], v[166:167] op_sel_hi:[1,0,1]
    v_pk_fma_f32 v[164:165], v[148:149], v[150:151], v[164:165] op_sel_hi:[1,0,1]
    v_pk_fma_f32 v[166:167], v[150:151], v[150:151], v[166:167] op_sel_hi:[1,0,1]
    v_mul_f32 v166, 0.5, v2
    s_waitcnt lgkmcnt(0)
    v_pk_mul_f32 v[160:161], v[120:121], v[126:127] op_sel_hi:[1,0]
    v_pk_mul_f32 v[162:163], v[122:123], v[126:127] op_sel_hi:[1,0]
    v_pk_fma_f32 v[160:161], v[128:129], v[134:135], v[160:161] op_sel_hi:[1,0,1]
    v_pk_fma_f32 v[162:163], v[130:131], v[134:135], v[162:163] op_sel_hi:[1,0,1]
    v_pk_fma_f32 v[160:161], v[136:137], v[142:143], v[160:161] op_sel_hi:[1,0,1]
    v_pk_fma_f32 v[162:163], v[138:139], v[142:143], v[162:163] op_sel_hi:[1,0,1]
    v_pk_fma_f32 v[160:161], v[144:145], v[150:151], v[160:161] op_sel_hi:[1,0,1]
    v_pk_fma_f32 v[162:163], v[146:147], v[150:151], v[162:163] op_sel_hi:[1,0,1]
    v_permlane32_swap_b32 v164, v166
    v_permlane32_swap_b32 v165, v167
    v_permlane32_swap_b32 v160, v162
    v_permlane32_swap_b32 v161, v163
    v_add_f32 v156, v164, v166
    v_add_f32 v158, v165, v167
    buffer_store_dwordx4 v[156:159], v246, s[16:19], s58 offen offset:1024 sc1
    v_add_f32 v152, v160, v162
    v_add_f32 v154, v161, v163
    buffer_store_dwordx4 v[152:155], v246, s[16:19], s58 offen sc1
L_wait3:
    s_cmp_ge_u32 s5, 5
    s_cbranch_scc1 L_fin
    s_barrier
    s_branch L_fin
L_coord:
    s_setprio 3
    s_mov_b32 s20, s42
    s_mov_b32 s21, s43
    s_mov_b32 s22, 0x780000
    s_mov_b32 s23, 0x20000
    s_mov_b32 s24, s36
    s_mov_b32 s25, s37
    s_mov_b32 s26, 0x500
    s_mov_b32 s27, 0x20000
    s_mov_b32 s16, s50
    s_mov_b32 s17, s51
    s_mov_b32 s18, 0x800000
    s_mov_b32 s19, 0x20000
    s_load_dword s32, s[50:51], 0
    v_mul_u32_u24 v6, 20, v242
    s_mul_i32 s6, s5, 160
    buffer_load_dwordx4 v[12:15], v6, s[24:27], s6 offen
    buffer_load_dword v16, v6, s[24:27], s6 offen offset:16
    s_mov_b32 s7, 122880
    v_mul_lo_u32 v5, v242, s7
    v_add_u32 v1, v5, v243
    s_mul_i32 s28, s5, 983040
    s_mul_i32 s7, s4, 384
    s_add_u32 s28, s28, s7
    v_mov_b32 v9, 0
    v_mov_b32 v8, 0
    ds_write_b64 v241, v[8:9] offset:384
    buffer_load_dwordx4 v[48:51], v1, s[20:23], s28 offen offset:0 nt
    buffer_load_dwordx4 v[52:55], v1, s[20:23], s28 offen offset:128 nt
    buffer_load_dwordx4 v[56:59], v1, s[20:23], s28 offen offset:256 nt
    s_add_u32 s28, s28, 12288
    buffer_load_dwordx4 v[60:63], v1, s[20:23], s28 offen offset:0 nt
    buffer_load_dwordx4 v[64:67], v1, s[20:23], s28 offen offset:128 nt
    buffer_load_dwordx4 v[68:71], v1, s[20:23], s28 offen offset:256 nt
    s_add_u32 s28, s28, 12288
    buffer_load_dwordx4 v[72:75], v1, s[20:23], s28 offen offset:0 nt
    buffer_load_dwordx4 v[76:79], v1, s[20:23], s28 offen offset:128 nt
    buffer_load_dwordx4 v[80:83], v1, s[20:23], s28 offen offset:256 nt
    s_add_u32 s28, s28, 12288
    buffer_load_dwordx4 v[84:87], v1, s[20:23], s28 offen offset:0 nt
    buffer_load_dwordx4 v[88:91], v1, s[20:23], s28 offen offset:128 nt
    buffer_load_dwordx4 v[92:95], v1, s[20:23], s28 offen offset:256 nt
    s_add_u32 s28, s28, 12288
    buffer_load_dwordx4 v[96:99], v1, s[20:23], s28 offen offset:0 nt
    buffer_load_dwordx4 v[100:103], v1, s[20:23], s28 offen offset:128 nt
    buffer_load_dwordx4 v[104:107], v1, s[20:23], s28 offen offset:256 nt
    s_add_u32 s28, s28, 12288
    buffer_load_dwordx4 v[108:111], v1, s[20:23], s28 offen offset:0 nt
    buffer_load_dwordx4 v[112:115], v1, s[20:23], s28 offen offset:128 nt
    buffer_load_dwordx4 v[116:119], v1, s[20:23], s28 offen offset:256 nt
    s_add_u32 s28, s28, 12288
    buffer_load_dwordx4 v[120:123], v1, s[20:23], s28 offen offset:0 nt
    buffer_load_dwordx4 v[124:127], v1, s[20:23], s28 offen offset:128 nt
    buffer_load_dwordx4 v[128:131], v1, s[20:23], s28 offen offset:256 nt
    s_add_u32 s28, s28, 12288
    buffer_load_dwordx4 v[132:135], v1, s[20:23], s28 offen offset:0 nt
    buffer_load_dwordx4 v[136:139], v1, s[20:23], s28 offen offset:128 nt
    buffer_load_dwordx4 v[140:143], v1, s[20:23], s28 offen offset:256 nt
    s_add_u32 s28, s28, 12288
    buffer_load_dwordx4 v[144:147], v1, s[20:23], s28 offen offset:0 nt
    buffer_load_dwordx4 v[148:151], v1, s[20:23], s28 offen offset:128 nt
    buffer_load_dwordx4 v[152:155], v1, s[20:23], s28 offen offset:256 nt
    s_add_u32 s28, s28, 12288
    buffer_load_dwordx4 v[156:159], v1, s[20:23], s28 offen offset:0 nt
    buffer_load_dwordx4 v[160:163], v1, s[20:23], s28 offen offset:128 nt
    buffer_load_dwordx4 v[164:167], v1, s[20:23], s28 offen offset:256 nt
    s_mul_i32 s35, s4, 256
    s_add_u32 s35, s35, 1310720
    s_cmp_lg_u32 s5, 0
    s_cbranch_scc1 L_noz
    v_and_b32 v7, 7, v240
    v_mul_u32_u24 v7, 8192, v7
    buffer_store_dword v241, v7, s[16:19], s35 offen sc1
L_noz:
    s_waitcnt lgkmcnt(0)
    s_barrier
    v_lshlrev_b32 v6, 4, v240
    v_lshrrev_b32 v7, 1, v240
    v_lshlrev_b32 v7, 6, v7
    v_and_b32 v8, 1, v240
    v_lshlrev_b32 v8, 2, v8
    v_add_u32 v7, v7, v8
    s_mul_i32 s57, s4, 88
    s_mul_i32 s6, s5, 8
    s_add_u32 s6, s6, s57
    s_add_u32 s6, s6, 448
    s_add_u32 s57, s57, 3072
    s_mov_b32 s56, s31
    v_add_u32 v7, s6, v7
    v_mov_b32 v20, -1
    v_mov_b32 v21, -1
    v_mov_b32 v22, -1
    v_mov_b32 v23, -1
    ds_write_b128 v6, v[20:23] offset:11776
    ds_write_b128 v6, v[20:23] offset:12800
    ds_write_b128 v6, v[20:23] offset:13824
    ds_write_b128 v6, v[20:23] offset:14848
    ds_write_b128 v6, v[20:23] offset:15872
    ds_write_b128 v6, v[20:23] offset:16896
    ds_write_b128 v6, v[20:23] offset:17920
    ds_write_b128 v6, v[20:23] offset:18944
    ds_write_b128 v6, v[20:23] offset:19968
    ds_write_b128 v6, v[20:23] offset:20992
    ds_write_b128 v6, v[20:23] offset:22016
    ds_write_b128 v6, v[20:23] offset:23040
    ds_write_b128 v6, v[20:23] offset:24064
    ds_write_b128 v6, v[20:23] offset:25088
    ds_write_b128 v6, v[20:23] offset:26112
    ds_write_b128 v6, v[20:23] offset:27136
    v_add_u32 v9, 0, v240
    v_subrev_u32 v8, 41, v9
    v_cmp_le_u32 vcc, 41, v9
    v_min_u32 v9, v9, v8
    v_lshl_add_u32 v8, v9, 6, s6
    v_and_b32 v8, 4095, v8
    v_mul_u32_u24 v8, 3072, v8
    v_lshl_add_u32 v8, v9, 4, v8
    v_addc_co_u32 v8, vcc, 1, v8, vcc
    v_add_u32 v184, s31, v8
    v_add_u32 v185, 0x1804, v184
    v_add_u32 v186, 0x3008, v184
    v_add_u32 v187, 0x480c, v184
    ds_write_b128 v6, v[184:187] offset:10752
    v_add_u32 v9, 64, v240
    v_subrev_u32 v8, 41, v9
    v_cmp_le_u32 vcc, 41, v9
    v_min_u32 v9, v9, v8
    v_lshl_add_u32 v8, v9, 6, s6
    v_and_b32 v8, 4095, v8
    v_mul_u32_u24 v8, 3072, v8
    v_lshl_add_u32 v8, v9, 4, v8
    v_addc_co_u32 v8, vcc, 1, v8, vcc
    v_add_u32 v188, s31, v8
    v_add_u32 v189, 0x1804, v188
    v_add_u32 v190, 0x3008, v188
    v_add_u32 v191, 0x480c, v188
    s_mov_b32 exec_lo, 0x3ffff
    s_mov_b32 exec_hi, 0x0
    ds_write_b128 v6, v[188:191] offset:11776
    s_mov_b64 exec, -1
    v_mov_b32 v24, 0
    v_mov_b32 v25, 0
    v_mov_b32 v26, 0
    v_mov_b32 v27, 0
    v_mov_b32 v28, 0
    v_mov_b32 v29, 0
    v_mov_b32 v30, 0
    v_mov_b32 v31, 0
    v_mov_b32 v32, 0
    v_mov_b32 v33, 0
    v_mov_b32 v34, 0
    v_mov_b32 v35, 0
    v_mov_b32 v36, 0
    v_mov_b32 v37, 0
    v_mov_b32 v38, 0
    v_mov_b32 v39, 0
    v_mov_b32 v40, 0
    v_mov_b32 v41, 0
    v_mov_b32 v42, 0
    v_mov_b32 v43, 0
    v_mov_b32 v44, 0
    v_mov_b32 v45, 0
    v_mov_b32 v46, 0
    v_mov_b32 v47, 0
    v_mov_b32 v8, 0xff7fffff
    v_cmp_lt_u32 vcc, 31, v240
    v_mov_b32 v20, 0
    v_mov_b32 v21, 0
    v_mov_b32 v23, 0
    v_cndmask_b32 v22, 0, v8, vcc
    ds_write_b128 v6, v[20:23] offset:512
    s_mul_i32 s32, s32, 0x9E3779B1
    s_add_u32 s32, s32, 0x7F4A7C15
    s_mov_b32 s6, 0x05040100
    s_mov_b32 s7, 0x07060302
    s_waitcnt vmcnt(24)
    v_perm_b32 v176, v60, v48, s6
    v_perm_b32 v177, v60, v48, s7
    v_dot2_f32_bf16 v24, v176, v12, v24
    v_dot2_f32_bf16 v25, v177, v12, v25
    v_perm_b32 v178, v61, v49, s6
    v_perm_b32 v179, v61, v49, s7
    v_dot2_f32_bf16 v26, v178, v12, v26
    v_dot2_f32_bf16 v27, v179, v12, v27
    v_perm_b32 v180, v62, v50, s6
    v_perm_b32 v181, v62, v50, s7
    v_dot2_f32_bf16 v28, v180, v12, v28
    v_dot2_f32_bf16 v29, v181, v12, v29
    v_perm_b32 v182, v63, v51, s6
    v_perm_b32 v183, v63, v51, s7
    v_dot2_f32_bf16 v30, v182, v12, v30
    v_dot2_f32_bf16 v31, v183, v12, v31
    v_perm_b32 v176, v64, v52, s6
    v_perm_b32 v177, v64, v52, s7
    v_dot2_f32_bf16 v32, v176, v12, v32
    v_dot2_f32_bf16 v33, v177, v12, v33
    v_perm_b32 v178, v65, v53, s6
    v_perm_b32 v179, v65, v53, s7
    v_dot2_f32_bf16 v34, v178, v12, v34
    v_dot2_f32_bf16 v35, v179, v12, v35
    v_perm_b32 v180, v66, v54, s6
    v_perm_b32 v181, v66, v54, s7
    v_dot2_f32_bf16 v36, v180, v12, v36
    v_dot2_f32_bf16 v37, v181, v12, v37
    v_perm_b32 v182, v67, v55, s6
    v_perm_b32 v183, v67, v55, s7
    v_dot2_f32_bf16 v38, v182, v12, v38
    v_dot2_f32_bf16 v39, v183, v12, v39
    v_perm_b32 v176, v68, v56, s6
    v_perm_b32 v177, v68, v56, s7
    v_dot2_f32_bf16 v40, v176, v12, v40
    v_dot2_f32_bf16 v41, v177, v12, v41
    v_perm_b32 v178, v69, v57, s6
    v_perm_b32 v179, v69, v57, s7
    v_dot2_f32_bf16 v42, v178, v12, v42
    v_dot2_f32_bf16 v43, v179, v12, v43
    v_perm_b32 v180, v70, v58, s6
    v_perm_b32 v181, v70, v58, s7
    v_dot2_f32_bf16 v44, v180, v12, v44
    v_dot2_f32_bf16 v45, v181, v12, v45
    v_perm_b32 v182, v71, v59, s6
    v_perm_b32 v183, v71, v59, s7
    v_dot2_f32_bf16 v46, v182, v12, v46
    v_dot2_f32_bf16 v47, v183, v12, v47
    s_waitcnt vmcnt(18)
    v_perm_b32 v176, v84, v72, s6
    v_perm_b32 v177, v84, v72, s7
    v_dot2_f32_bf16 v24, v176, v13, v24
    v_dot2_f32_bf16 v25, v177, v13, v25
    v_perm_b32 v178, v85, v73, s6
    v_perm_b32 v179, v85, v73, s7
    v_dot2_f32_bf16 v26, v178, v13, v26
    v_dot2_f32_bf16 v27, v179, v13, v27
    v_perm_b32 v180, v86, v74, s6
    v_perm_b32 v181, v86, v74, s7
    v_dot2_f32_bf16 v28, v180, v13, v28
    v_dot2_f32_bf16 v29, v181, v13, v29
    v_perm_b32 v182, v87, v75, s6
    v_perm_b32 v183, v87, v75, s7
    v_dot2_f32_bf16 v30, v182, v13, v30
    v_dot2_f32_bf16 v31, v183, v13, v31
    v_perm_b32 v176, v88, v76, s6
    v_perm_b32 v177, v88, v76, s7
    v_dot2_f32_bf16 v32, v176, v13, v32
    v_dot2_f32_bf16 v33, v177, v13, v33
    v_perm_b32 v178, v89, v77, s6
    v_perm_b32 v179, v89, v77, s7
    v_dot2_f32_bf16 v34, v178, v13, v34
    v_dot2_f32_bf16 v35, v179, v13, v35
    v_perm_b32 v180, v90, v78, s6
    v_perm_b32 v181, v90, v78, s7
    v_dot2_f32_bf16 v36, v180, v13, v36
    v_dot2_f32_bf16 v37, v181, v13, v37
    v_perm_b32 v182, v91, v79, s6
    v_perm_b32 v183, v91, v79, s7
    v_dot2_f32_bf16 v38, v182, v13, v38
    v_dot2_f32_bf16 v39, v183, v13, v39
    v_perm_b32 v176, v92, v80, s6
    v_perm_b32 v177, v92, v80, s7
    v_dot2_f32_bf16 v40, v176, v13, v40
    v_dot2_f32_bf16 v41, v177, v13, v41
    v_perm_b32 v178, v93, v81, s6
    v_perm_b32 v179, v93, v81, s7
    v_dot2_f32_bf16 v42, v178, v13, v42
    v_dot2_f32_bf16 v43, v179, v13, v43
    v_perm_b32 v180, v94, v82, s6
    v_perm_b32 v181, v94, v82, s7
    v_dot2_f32_bf16 v44, v180, v13, v44
    v_dot2_f32_bf16 v45, v181, v13, v45
    v_perm_b32 v182, v95, v83, s6
    v_perm_b32 v183, v95, v83, s7
    v_dot2_f32_bf16 v46, v182, v13, v46
    v_dot2_f32_bf16 v47, v183, v13, v47
    s_waitcnt vmcnt(12)
    v_perm_b32 v176, v108, v96, s6
    v_perm_b32 v177, v108, v96, s7
    v_dot2_f32_bf16 v24, v176, v14, v24
    v_dot2_f32_bf16 v25, v177, v14, v25
    v_perm_b32 v178, v109, v97, s6
    v_perm_b32 v179, v109, v97, s7
    v_dot2_f32_bf16 v26, v178, v14, v26
    v_dot2_f32_bf16 v27, v179, v14, v27
    v_perm_b32 v180, v110, v98, s6
    v_perm_b32 v181, v110, v98, s7
    v_dot2_f32_bf16 v28, v180, v14, v28
    v_dot2_f32_bf16 v29, v181, v14, v29
    v_perm_b32 v182, v111, v99, s6
    v_perm_b32 v183, v111, v99, s7
    v_dot2_f32_bf16 v30, v182, v14, v30
    v_dot2_f32_bf16 v31, v183, v14, v31
    v_perm_b32 v176, v112, v100, s6
    v_perm_b32 v177, v112, v100, s7
    v_dot2_f32_bf16 v32, v176, v14, v32
    v_dot2_f32_bf16 v33, v177, v14, v33
    v_perm_b32 v178, v113, v101, s6
    v_perm_b32 v179, v113, v101, s7
    v_dot2_f32_bf16 v34, v178, v14, v34
    v_dot2_f32_bf16 v35, v179, v14, v35
    v_perm_b32 v180, v114, v102, s6
    v_perm_b32 v181, v114, v102, s7
    v_dot2_f32_bf16 v36, v180, v14, v36
    v_dot2_f32_bf16 v37, v181, v14, v37
    v_perm_b32 v182, v115, v103, s6
    v_perm_b32 v183, v115, v103, s7
    v_dot2_f32_bf16 v38, v182, v14, v38
    v_dot2_f32_bf16 v39, v183, v14, v39
    v_perm_b32 v176, v116, v104, s6
    v_perm_b32 v177, v116, v104, s7
    v_dot2_f32_bf16 v40, v176, v14, v40
    v_dot2_f32_bf16 v41, v177, v14, v41
    v_perm_b32 v178, v117, v105, s6
    v_perm_b32 v179, v117, v105, s7
    v_dot2_f32_bf16 v42, v178, v14, v42
    v_dot2_f32_bf16 v43, v179, v14, v43
    v_perm_b32 v180, v118, v106, s6
    v_perm_b32 v181, v118, v106, s7
    v_dot2_f32_bf16 v44, v180, v14, v44
    v_dot2_f32_bf16 v45, v181, v14, v45
    v_perm_b32 v182, v119, v107, s6
    v_perm_b32 v183, v119, v107, s7
    v_dot2_f32_bf16 v46, v182, v14, v46
    v_dot2_f32_bf16 v47, v183, v14, v47
    s_waitcnt vmcnt(6)
    v_perm_b32 v176, v132, v120, s6
    v_perm_b32 v177, v132, v120, s7
    v_dot2_f32_bf16 v24, v176, v15, v24
    v_dot2_f32_bf16 v25, v177, v15, v25
    v_perm_b32 v178, v133, v121, s6
    v_perm_b32 v179, v133, v121, s7
    v_dot2_f32_bf16 v26, v178, v15, v26
    v_dot2_f32_bf16 v27, v179, v15, v27
    v_perm_b32 v180, v134, v122, s6
    v_perm_b32 v181, v134, v122, s7
    v_dot2_f32_bf16 v28, v180, v15, v28
    v_dot2_f32_bf16 v29, v181, v15, v29
    v_perm_b32 v182, v135, v123, s6
    v_perm_b32 v183, v135, v123, s7
    v_dot2_f32_bf16 v30, v182, v15, v30
    v_dot2_f32_bf16 v31, v183, v15, v31
    v_perm_b32 v176, v136, v124, s6
    v_perm_b32 v177, v136, v124, s7
    v_dot2_f32_bf16 v32, v176, v15, v32
    v_dot2_f32_bf16 v33, v177, v15, v33
    v_perm_b32 v178, v137, v125, s6
    v_perm_b32 v179, v137, v125, s7
    v_dot2_f32_bf16 v34, v178, v15, v34
    v_dot2_f32_bf16 v35, v179, v15, v35
    v_perm_b32 v180, v138, v126, s6
    v_perm_b32 v181, v138, v126, s7
    v_dot2_f32_bf16 v36, v180, v15, v36
    v_dot2_f32_bf16 v37, v181, v15, v37
    v_perm_b32 v182, v139, v127, s6
    v_perm_b32 v183, v139, v127, s7
    v_dot2_f32_bf16 v38, v182, v15, v38
    v_dot2_f32_bf16 v39, v183, v15, v39
    v_perm_b32 v176, v140, v128, s6
    v_perm_b32 v177, v140, v128, s7
    v_dot2_f32_bf16 v40, v176, v15, v40
    v_dot2_f32_bf16 v41, v177, v15, v41
    v_perm_b32 v178, v141, v129, s6
    v_perm_b32 v179, v141, v129, s7
    v_dot2_f32_bf16 v42, v178, v15, v42
    v_dot2_f32_bf16 v43, v179, v15, v43
    v_perm_b32 v180, v142, v130, s6
    v_perm_b32 v181, v142, v130, s7
    v_dot2_f32_bf16 v44, v180, v15, v44
    v_dot2_f32_bf16 v45, v181, v15, v45
    v_perm_b32 v182, v143, v131, s6
    v_perm_b32 v183, v143, v131, s7
    v_dot2_f32_bf16 v46, v182, v15, v46
    v_dot2_f32_bf16 v47, v183, v15, v47
    s_waitcnt vmcnt(0)
    v_perm_b32 v176, v156, v144, s6
    v_perm_b32 v177, v156, v144, s7
    v_dot2_f32_bf16 v24, v176, v16, v24
    v_dot2_f32_bf16 v25, v177, v16, v25
    v_perm_b32 v178, v157, v145, s6
    v_perm_b32 v179, v157, v145, s7
    v_dot2_f32_bf16 v26, v178, v16, v26
    v_dot2_f32_bf16 v27, v179, v16, v27
    v_perm_b32 v180, v158, v146, s6
    v_perm_b32 v181, v158, v146, s7
    v_dot2_f32_bf16 v28, v180, v16, v28
    v_dot2_f32_bf16 v29, v181, v16, v29
    v_perm_b32 v182, v159, v147, s6
    v_perm_b32 v183, v159, v147, s7
    v_dot2_f32_bf16 v30, v182, v16, v30
    v_dot2_f32_bf16 v31, v183, v16, v31
    v_perm_b32 v176, v160, v148, s6
    v_perm_b32 v177, v160, v148, s7
    v_dot2_f32_bf16 v32, v176, v16, v32
    v_dot2_f32_bf16 v33, v177, v16, v33
    v_perm_b32 v178, v161, v149, s6
    v_perm_b32 v179, v161, v149, s7
    v_dot2_f32_bf16 v34, v178, v16, v34
    v_dot2_f32_bf16 v35, v179, v16, v35
    v_perm_b32 v180, v162, v150, s6
    v_perm_b32 v181, v162, v150, s7
    v_dot2_f32_bf16 v36, v180, v16, v36
    v_dot2_f32_bf16 v37, v181, v16, v37
    v_perm_b32 v182, v163, v151, s6
    v_perm_b32 v183, v163, v151, s7
    v_dot2_f32_bf16 v38, v182, v16, v38
    v_dot2_f32_bf16 v39, v183, v16, v39
    v_perm_b32 v176, v164, v152, s6
    v_perm_b32 v177, v164, v152, s7
    v_dot2_f32_bf16 v40, v176, v16, v40
    v_dot2_f32_bf16 v41, v177, v16, v41
    v_perm_b32 v178, v165, v153, s6
    v_perm_b32 v179, v165, v153, s7
    v_dot2_f32_bf16 v42, v178, v16, v42
    v_dot2_f32_bf16 v43, v179, v16, v43
    v_perm_b32 v180, v166, v154, s6
    v_perm_b32 v181, v166, v154, s7
    v_dot2_f32_bf16 v44, v180, v16, v44
    v_dot2_f32_bf16 v45, v181, v16, v45
    v_perm_b32 v182, v167, v155, s6
    v_perm_b32 v183, v167, v155, s7
    v_dot2_f32_bf16 v46, v182, v16, v46
    v_dot2_f32_bf16 v47, v183, v16, v47
    v_permlane32_swap_b32 v24, v36
    v_permlane32_swap_b32 v25, v37
    v_permlane32_swap_b32 v26, v38
    v_permlane32_swap_b32 v27, v39
    v_permlane32_swap_b32 v28, v40
    v_permlane32_swap_b32 v29, v41
    v_permlane32_swap_b32 v30, v42
    v_permlane32_swap_b32 v31, v43
    v_permlane32_swap_b32 v32, v44
    v_permlane32_swap_b32 v33, v45
    v_permlane32_swap_b32 v34, v46
    v_permlane32_swap_b32 v35, v47
    v_pk_add_f32 v[24:25], v[24:25], v[36:37]
    v_pk_add_f32 v[26:27], v[26:27], v[38:39]
    v_pk_add_f32 v[28:29], v[28:29], v[40:41]
    v_pk_add_f32 v[30:31], v[30:31], v[42:43]
    v_pk_add_f32 v[32:33], v[32:33], v[44:45]
    v_pk_add_f32 v[34:35], v[34:35], v[46:47]
    v_permlane16_swap_b32 v24, v30
    v_permlane16_swap_b32 v25, v31
    v_permlane16_swap_b32 v26, v32
    v_permlane16_swap_b32 v27, v33
    v_permlane16_swap_b32 v28, v34
    v_permlane16_swap_b32 v29, v35
    v_pk_add_f32 v[24:25], v[24:25], v[30:31]
    v_pk_add_f32 v[26:27], v[26:27], v[32:33]
    v_pk_add_f32 v[28:29], v[28:29], v[34:35]
    v_add_f32_dpp v24, v24, v24 row_ror:8 row_mask:0xf bank_mask:0xf
    v_add_f32_dpp v25, v25, v25 row_ror:8 row_mask:0xf bank_mask:0xf
    v_add_f32_dpp v26, v26, v26 row_ror:8 row_mask:0xf bank_mask:0xf
    v_add_f32_dpp v27, v27, v27 row_ror:8 row_mask:0xf bank_mask:0xf
    v_add_f32_dpp v28, v28, v28 row_ror:8 row_mask:0xf bank_mask:0xf
    v_add_f32_dpp v29, v29, v29 row_ror:8 row_mask:0xf bank_mask:0xf
    v_lshrrev_b32 v5, 4, v240
    v_lshlrev_b32 v5, 7, v5
    v_add_u32 v5, v5, v243
    s_lshl_b32 s6, s2, 11
    s_add_u32 s6, s6, 65536
    v_mov_b32 v48, v24
    v_mov_b32 v49, s32
    v_mov_b32 v50, v25
    v_mov_b32 v51, s32
    buffer_store_dwordx4 v[48:51], v5, s[16:19], s6 offen offset:0 sc1
    v_mov_b32 v52, v26
    v_mov_b32 v53, s32
    v_mov_b32 v54, v27
    v_mov_b32 v55, s32
    buffer_store_dwordx4 v[52:55], v5, s[16:19], s6 offen offset:512 sc1
    v_mov_b32 v56, v28
    v_mov_b32 v57, s32
    v_mov_b32 v58, v29
    v_mov_b32 v59, s32
    buffer_store_dwordx4 v[56:59], v5, s[16:19], s6 offen offset:1024 sc1
    v_and_b32 v5, 31, v240
    v_lshlrev_b32 v5, 4, v5
    v_lshrrev_b32 v6, 5, v240
    v_lshlrev_b32 v6, 11, v6
    v_add_u32 v5, v5, v6
    s_lshl_b32 s6, s4, 14
    s_add_u32 s6, s6, 65536
    s_mov_b32 s52, 200000
L_pq:
    s_mov_b32 s28, s6
    buffer_load_dwordx4 v[64:67], v5, s[16:19], s28 offen offset:0 sc1
    buffer_load_dwordx4 v[68:71], v5, s[16:19], s28 offen offset:512 sc1
    buffer_load_dwordx4 v[72:75], v5, s[16:19], s28 offen offset:1024 sc1
    s_add_u32 s28, s28, 4096
    buffer_load_dwordx4 v[76:79], v5, s[16:19], s28 offen offset:0 sc1
    buffer_load_dwordx4 v[80:83], v5, s[16:19], s28 offen offset:512 sc1
    buffer_load_dwordx4 v[84:87], v5, s[16:19], s28 offen offset:1024 sc1
    s_add_u32 s28, s28, 4096
    buffer_load_dwordx4 v[88:91], v5, s[16:19], s28 offen offset:0 sc1
    buffer_load_dwordx4 v[92:95], v5, s[16:19], s28 offen offset:512 sc1
    buffer_load_dwordx4 v[96:99], v5, s[16:19], s28 offen offset:1024 sc1
    s_add_u32 s28, s28, 4096
    buffer_load_dwordx4 v[100:103], v5, s[16:19], s28 offen offset:0 sc1
    buffer_load_dwordx4 v[104:107], v5, s[16:19], s28 offen offset:512 sc1
    buffer_load_dwordx4 v[108:111], v5, s[16:19], s28 offen offset:1024 sc1
    s_waitcnt vmcnt(0)
    v_bitop3_b32 v2, v65, v67, s32 bitop3:0x7e
    v_bitop3_b32 v2, v2, v69, s32 bitop3:0xf6
    v_bitop3_b32 v2, v2, v71, s32 bitop3:0xf6
    v_bitop3_b32 v2, v2, v73, s32 bitop3:0xf6
    v_bitop3_b32 v2, v2, v75, s32 bitop3:0xf6
    v_bitop3_b32 v2, v2, v77, s32 bitop3:0xf6
    v_bitop3_b32 v2, v2, v79, s32 bitop3:0xf6
    v_bitop3_b32 v2, v2, v81, s32 bitop3:0xf6
    v_bitop3_b32 v2, v2, v83, s32 bitop3:0xf6
    v_bitop3_b32 v2, v2, v85, s32 bitop3:0xf6
    v_bitop3_b32 v2, v2, v87, s32 bitop3:0xf6
    v_bitop3_b32 v2, v2, v89, s32 bitop3:0xf6
    v_bitop3_b32 v2, v2, v91, s32 bitop3:0xf6
    v_bitop3_b32 v2, v2, v93, s32 bitop3:0xf6
    v_bitop3_b32 v2, v2, v95, s32 bitop3:0xf6
    v_bitop3_b32 v2, v2, v97, s32 bitop3:0xf6
    v_bitop3_b32 v2, v2, v99, s32 bitop3:0xf6
    v_bitop3_b32 v2, v2, v101, s32 bitop3:0xf6
    v_bitop3_b32 v2, v2, v103, s32 bitop3:0xf6
    v_bitop3_b32 v2, v2, v105, s32 bitop3:0xf6
    v_bitop3_b32 v2, v2, v107, s32 bitop3:0xf6
    v_bitop3_b32 v2, v2, v109, s32 bitop3:0xf6
    v_bitop3_b32 v2, v2, v111, s32 bitop3:0xf6
    v_cmp_ne_u32 vcc, 0, v2
    s_cbranch_vccz L_pq_ok
    s_mov_b64 exec, vcc
    s_sub_u32 s52, s52, 1
    s_cmp_lg_u32 s52, 0
    s_cbranch_scc1 L_pq
L_pq_ok:
    s_mov_b64 exec, -1
    v_add_f32 v64, v64, v76
    v_add_f32 v88, v88, v100
    v_add_f32 v66, v66, v78
    v_add_f32 v90, v90, v102
    v_add_f32 v68, v68, v80
    v_add_f32 v92, v92, v104
    v_add_f32 v70, v70, v82
    v_add_f32 v94, v94, v106
    v_add_f32 v72, v72, v84
    v_add_f32 v96, v96, v108
    v_add_f32 v74, v74, v86
    v_add_f32 v98, v98, v110
    v_add_f32 v64, v64, v88
    v_add_f32 v66, v66, v90
    v_add_f32 v68, v68, v92
    v_add_f32 v70, v70, v94
    v_add_f32 v72, v72, v96
    v_add_f32 v74, v74, v98
    v_mov_b32 v65, v64
    v_mov_b32 v67, v66
    v_mov_b32 v69, v68
    v_mov_b32 v71, v70
    v_mov_b32 v73, v72
    v_mov_b32 v75, v74
    v_permlane32_swap_b32 v64, v65
    v_permlane32_swap_b32 v66, v67
    v_permlane32_swap_b32 v68, v69
    v_permlane32_swap_b32 v70, v71
    v_permlane32_swap_b32 v72, v73
    v_permlane32_swap_b32 v74, v75
    v_add_f32 v64, v64, v65
    v_add_f32 v66, v66, v67
    v_add_f32 v68, v68, v69
    v_add_f32 v70, v70, v71
    v_add_f32 v72, v72, v73
    v_add_f32 v74, v74, v75
    v_and_b32 v5, 3, v242
    v_mul_u32_u24 v5, 6, v5
    v_cvt_pk_bf16_f32 v65, v64, v66
    v_add_u32 v6, 0, v5
    v_lshrrev_b32 v2, 3, v6
    v_lshlrev_b32 v2, 7, v2
    v_and_b32 v6, 7, v6
    v_lshlrev_b32 v6, 1, v6
    v_add3_u32 v2, v2, v6, v243
    ds_write_b32 v2, v65 offset:0
    v_cvt_pk_bf16_f32 v65, v68, v70
    v_add_u32 v6, 2, v5
    v_lshrrev_b32 v2, 3, v6
    v_lshlrev_b32 v2, 7, v2
    v_and_b32 v6, 7, v6
    v_lshlrev_b32 v6, 1, v6
    v_add3_u32 v2, v2, v6, v243
    ds_write_b32 v2, v65 offset:0
    v_cvt_pk_bf16_f32 v65, v72, v74
    v_add_u32 v6, 4, v5
    v_lshrrev_b32 v2, 3, v6
    v_lshlrev_b32 v2, 7, v2
    v_and_b32 v6, 7, v6
    v_lshlrev_b32 v6, 1, v6
    v_add3_u32 v2, v2, v6, v243
    ds_write_b32 v2, v65 offset:0
    v_mov_b32 v5, 1
    ds_write_b32 v241, v5 offset:384
    s_setprio 0
L_help:
    s_waitcnt vmcnt(0)
    s_cmp_ge_u32 s5, 5
    s_cbranch_scc1 L_help_no
    s_mov_b32 s20, s44
    s_mov_b32 s21, s45
    s_mov_b32 s22, 0x780000
    s_mov_b32 s23, 0x20000
    v_lshlrev_b32 v5, 2, v240
    s_mul_i32 s31, s4, 245760
    s_lshl_b32 s6, s5, 8
    s_add_u32 s31, s31, s6
    s_mul_i32 s6, s3, 6
    s_add_u32 s6, s6, 0
    s_lshr_b32 s7, s6, 3
    s_lshl_b32 s7, s7, 6
    s_and_b32 s6, s6, 7
    s_add_u32 s6, s6, s7
    s_mul_i32 s6, s6, 1280
    s_add_u32 s6, s6, s31
    buffer_load_dword v48, v5, s[20:23], s6 offen nt
    buffer_load_dword v49, v5, s[20:23], s6 offen offset:1280 nt
    s_add_u32 s6, s6, 10240
    buffer_load_dword v50, v5, s[20:23], s6 offen nt
    buffer_load_dword v51, v5, s[20:23], s6 offen offset:1280 nt
    s_add_u32 s6, s6, 10240
    buffer_load_dword v52, v5, s[20:23], s6 offen nt
    buffer_load_dword v53, v5, s[20:23], s6 offen offset:1280 nt
    s_add_u32 s6, s6, 10240
    buffer_load_dword v54, v5, s[20:23], s6 offen nt
    buffer_load_dword v55, v5, s[20:23], s6 offen offset:1280 nt
    s_add_u32 s6, s6, 10240
    buffer_load_dword v56, v5, s[20:23], s6 offen nt
    buffer_load_dword v57, v5, s[20:23], s6 offen offset:1280 nt
    s_add_u32 s6, s6, 10240
    buffer_load_dword v58, v5, s[20:23], s6 offen nt
    buffer_load_dword v59, v5, s[20:23], s6 offen offset:1280 nt
    s_add_u32 s6, s6, 10240
    buffer_load_dword v60, v5, s[20:23], s6 offen nt
    buffer_load_dword v61, v5, s[20:23], s6 offen offset:1280 nt
    s_add_u32 s6, s6, 10240
    buffer_load_dword v62, v5, s[20:23], s6 offen nt
    buffer_load_dword v63, v5, s[20:23], s6 offen offset:1280 nt
    s_mul_i32 s6, s3, 6
    s_add_u32 s6, s6, 2
    s_lshr_b32 s7, s6, 3
    s_lshl_b32 s7, s7, 6
    s_and_b32 s6, s6, 7
    s_add_u32 s6, s6, s7
    s_mul_i32 s6, s6, 1280
    s_add_u32 s6, s6, s31
    buffer_load_dword v64, v5, s[20:23], s6 offen nt
    buffer_load_dword v65, v5, s[20:23], s6 offen offset:1280 nt
    s_add_u32 s6, s6, 10240
    buffer_load_dword v66, v5, s[20:23], s6 offen nt
    buffer_load_dword v67, v5, s[20:23], s6 offen offset:1280 nt
    s_add_u32 s6, s6, 10240
    buffer_load_dword v68, v5, s[20:23], s6 offen nt
    buffer_load_dword v69, v5, s[20:23], s6 offen offset:1280 nt
    s_add_u32 s6, s6, 10240
    buffer_load_dword v70, v5, s[20:23], s6 offen nt
    buffer_load_dword v71, v5, s[20:23], s6 offen offset:1280 nt
    s_add_u32 s6, s6, 10240
    buffer_load_dword v72, v5, s[20:23], s6 offen nt
    buffer_load_dword v73, v5, s[20:23], s6 offen offset:1280 nt
    s_add_u32 s6, s6, 10240
    buffer_load_dword v74, v5, s[20:23], s6 offen nt
    buffer_load_dword v75, v5, s[20:23], s6 offen offset:1280 nt
    s_add_u32 s6, s6, 10240
    buffer_load_dword v76, v5, s[20:23], s6 offen nt
    buffer_load_dword v77, v5, s[20:23], s6 offen offset:1280 nt
    s_add_u32 s6, s6, 10240
    buffer_load_dword v78, v5, s[20:23], s6 offen nt
    buffer_load_dword v79, v5, s[20:23], s6 offen offset:1280 nt
    s_mul_i32 s6, s3, 6
    s_add_u32 s6, s6, 4
    s_lshr_b32 s7, s6, 3
    s_lshl_b32 s7, s7, 6
    s_and_b32 s6, s6, 7
    s_add_u32 s6, s6, s7
    s_mul_i32 s6, s6, 1280
    s_add_u32 s6, s6, s31
    buffer_load_dword v80, v5, s[20:23], s6 offen nt
    buffer_load_dword v81, v5, s[20:23], s6 offen offset:1280 nt
    s_add_u32 s6, s6, 10240
    buffer_load_dword v82, v5, s[20:23], s6 offen nt
    buffer_load_dword v83, v5, s[20:23], s6 offen offset:1280 nt
    s_add_u32 s6, s6, 10240
    buffer_load_dword v84, v5, s[20:23], s6 offen nt
    buffer_load_dword v85, v5, s[20:23], s6 offen offset:1280 nt
    s_add_u32 s6, s6, 10240
    buffer_load_dword v86, v5, s[20:23], s6 offen nt
    buffer_load_dword v87, v5, s[20:23], s6 offen offset:1280 nt
    s_add_u32 s6, s6, 10240
    buffer_load_dword v88, v5, s[20:23], s6 offen nt
    buffer_load_dword v89, v5, s[20:23], s6 offen offset:1280 nt
    s_add_u32 s6, s6, 10240
    buffer_load_dword v90, v5, s[20:23], s6 offen nt
    buffer_load_dword v91, v5, s[20:23], s6 offen offset:1280 nt
    s_add_u32 s6, s6, 10240
    buffer_load_dword v92, v5, s[20:23], s6 offen nt
    buffer_load_dword v93, v5, s[20:23], s6 offen offset:1280 nt
    s_add_u32 s6, s6, 10240
    buffer_load_dword v94, v5, s[20:23], s6 offen nt
    buffer_load_dword v95, v5, s[20:23], s6 offen offset:1280 nt
    v_lshlrev_b32 v2, 11, v242
    v_add_u32 v1, v2, v243
    s_lshl_b32 s58, s4, 14
    s_lshl_b32 s7, s3, 7
    s_add_u32 s58, s58, s7
    s_add_u32 s58, s58, 589824
    v_lshlrev_b32 v10, 3, v240
    s_lshl_b32 s7, s3, 9
    v_add_u32 v11, s7, v10
    v_lshlrev_b32 v7, 12, v242
    v_add_u32 v7, v7, v243
    s_lshl_b32 s59, s5, 15
    s_lshl_b32 s7, s4, 7
    s_add_u32 s59, s59, s7
    s_add_u32 s59, s59, 1114112
    s_mov_b32 s52, 200000
    s_mov_b32 s6, 0x05040100
    s_mov_b32 s7, 0x07060302
    s_waitcnt vmcnt(0)
    v_perm_b32 v96, v49, v48, s6
    v_perm_b32 v97, v49, v48, s7
    v_perm_b32 v98, v51, v50, s6
    v_perm_b32 v99, v51, v50, s7
    v_perm_b32 v100, v53, v52, s6
    v_perm_b32 v101, v53, v52, s7
    v_perm_b32 v102, v55, v54, s6
    v_perm_b32 v103, v55, v54, s7
    v_perm_b32 v104, v57, v56, s6
    v_perm_b32 v105, v57, v56, s7
    v_perm_b32 v106, v59, v58, s6
    v_perm_b32 v107, v59, v58, s7
    v_perm_b32 v108, v61, v60, s6
    v_perm_b32 v109, v61, v60, s7
    v_perm_b32 v110, v63, v62, s6
    v_perm_b32 v111, v63, v62, s7
    v_perm_b32 v112, v65, v64, s6
    v_perm_b32 v113, v65, v64, s7
    v_perm_b32 v114, v67, v66, s6
    v_perm_b32 v115, v67, v66, s7
    v_perm_b32 v116, v69, v68, s6
    v_perm_b32 v117, v69, v68, s7
    v_perm_b32 v118, v71, v70, s6
    v_perm_b32 v119, v71, v70, s7
    v_perm_b32 v120, v73, v72, s6
    v_perm_b32 v121, v73, v72, s7
    v_perm_b32 v122, v75, v74, s6
    v_perm_b32 v123, v75, v74, s7
    v_perm_b32 v124, v77, v76, s6
    v_perm_b32 v125, v77, v76, s7
    v_perm_b32 v126, v79, v78, s6
    v_perm_b32 v127, v79, v78, s7
    v_perm_b32 v128, v81, v80, s6
    v_perm_b32 v129, v81, v80, s7
    v_perm_b32 v130, v83, v82, s6
    v_perm_b32 v131, v83, v82, s7
    v_perm_b32 v132, v85, v84, s6
    v_perm_b32 v133, v85, v84, s7
    v_perm_b32 v134, v87, v86, s6
    v_perm_b32 v135, v87, v86, s7
    v_perm_b32 v136, v89, v88, s6
    v_perm_b32 v137, v89, v88, s7
    v_perm_b32 v138, v91, v90, s6
    v_perm_b32 v139, v91, v90, s7
    v_perm_b32 v140, v93, v92, s6
    v_perm_b32 v141, v93, v92, s7
    v_perm_b32 v142, v95, v94, s6
    v_perm_b32 v143, v95, v94, s7
    v_mov_b32 v29, s32
    v_mov_b32 v31, s32
    v_mov_b32 v32, 0
    v_mov_b32 v33, 0
    v_mov_b32 v34, 0
    v_mov_b32 v35, 0
    v_mov_b32 v36, 0
    v_mov_b32 v37, 0
    v_mov_b32 v38, 0xff7fffff
    v_mov_b32 v39, 0
    s_lshl_b32 s6, s5, 3
    s_mov_b64 s[94:95], 0xff
    s_lshl_b64 s[94:95], s[94:95], s6
    s_not_b64 s[94:95], s[94:95]
    v_lshlrev_b32 v8, 10, v242
    s_lshl_b32 s6, s3, 7
    v_add3_u32 v8, v8, v243, s6
    s_cmp_lg_u32 s3, 0
    s_cbranch_scc1 L_ma_out
    s_mov_b32 s53, 1312
    v_mul_u32_u24 v248, 3072, v240
    v_lshlrev_b32 v251, 2, v240
    s_mov_b32 s98, 0
L_ma_G:
    s_cmp_ge_u32 s98, 64
    s_cbranch_scc1 L_ma_last2
L_ma_w1:
    ds_read_b32 v244, v241 offset:388
    s_waitcnt lgkmcnt(0)
    v_readfirstlane_b32 s55, v244
    s_sub_u32 s55, s53, s55
    s_cmp_lt_i32 s55, 24
    s_cbranch_scc1 L_ma_w1_go
    s_sleep 2
    s_branch L_ma_w1
L_ma_w1_go:
L_ma_R:
    s_mov_b32 s55, 1
    s_atomic_add s55, s[50:51], s35 glc
    s_waitcnt lgkmcnt(0)
    s_mov_b32 s99, s98
    s_cmp_lt_u32 s55, 7
    s_cbranch_scc1 L_ma_T
    s_add_u32 s98, s98, 8
    s_add_u32 s35, s35, 8192
    s_cmp_eq_u32 s55, 7
    s_cbranch_scc1 L_ma_T
    s_cmp_lt_u32 s98, 64
    s_cbranch_scc1 L_ma_R
    s_branch L_ma_last2
L_ma_T:
    s_add_u32 s55, s55, s99
    s_lshr_b32 s93, s55, 3
    s_cmp_gt_u32 s93, 7
    s_cbranch_scc1 L_ma_last2
    s_lshr_b32 s92, 64, s93
    s_max_u32 s92, s92, 1
    s_and_b32 s55, s55, 7
    s_mul_i32 s55, s55, s92
    s_lshr_b32 s93, 1024, s93
    s_sub_u32 s55, s55, s93
    s_add_u32 s55, s55, 1024
    s_add_u32 s28, s55, s57
    v_add_u32 v249, s28, v240
    v_and_b32 v249, 4095, v249
    v_mul_u32_u24 v249, 3072, v249
    v_add_u32 v249, s56, v249
    v_add_u32 v244, s53, v251
    v_cmp_gt_u32 vcc, s92, v240
    s_mov_b64 exec, vcc
    ds_write_b32 v244, v249 offset:10752
    s_mov_b64 exec, -1
    s_lshl2_add_u32 s53, s92, s53
    s_branch L_ma_G
L_ma_last2:
    s_mov_b32 s55, 1024
L_ma_last:
    s_min_u32 s55, s55, 1024
    s_add_u32 s28, s55, s57
    v_add_u32 v249, s28, v240
    v_and_b32 v249, 4095, v249
    v_mul_u32_u24 v249, 3072, v249
    v_add_u32 v249, s56, v249
    s_sub_u32 s55, 1024, s55
    v_add_u32 v244, s53, v251
    v_mov_b32 v251, 0x7fffffff
    v_cmp_gt_u32 vcc, s55, v240
    s_nop 1
    v_cndmask_b32 v249, v251, v249, vcc
    ds_write_b32 v244, v249 offset:10752
    s_waitcnt vmcnt(0)
L_ma_out:
    s_waitcnt lgkmcnt(0)
    s_barrier
    ds_read_b128 v[40:43], v8 offset:512
    ds_read_b128 v[44:47], v8 offset:1024
    s_mov_b64 exec, s[94:95]
    buffer_load_dwordx4 v[144:147], v1, s[16:19], s58 offen offset:0 sc1
    buffer_load_dwordx4 v[148:151], v1, s[16:19], s58 offen offset:512 sc1
    buffer_load_dwordx4 v[152:155], v1, s[16:19], s58 offen offset:1024 sc1
    buffer_load_dwordx4 v[156:159], v1, s[16:19], s58 offen offset:1536 sc1
L_po:
    s_waitcnt vmcnt(0)
    v_bitop3_b32 v2, v145, v147, s32 bitop3:0x7e
    v_bitop3_b32 v2, v2, v149, s32 bitop3:0xf6
    v_bitop3_b32 v2, v2, v151, s32 bitop3:0xf6
    v_bitop3_b32 v2, v2, v153, s32 bitop3:0xf6
    v_bitop3_b32 v2, v2, v155, s32 bitop3:0xf6
    v_bitop3_b32 v2, v2, v157, s32 bitop3:0xf6
    v_bitop3_b32 v2, v2, v159, s32 bitop3:0xf6
    v_cmp_eq_u32 vcc, 0, v2
    s_cbranch_vccz L_po_n0
    s_mov_b64 exec, vcc
    v_mov_b32 v32, v144
    v_mov_b32 v33, v146
    v_mov_b32 v34, v148
    v_mov_b32 v35, v150
    v_mov_b32 v36, v152
    v_mov_b32 v37, v154
    v_mov_b32 v38, v156
    v_mov_b32 v39, v158
    s_andn2_b64 s[94:95], s[94:95], vcc
    s_cbranch_scc0 L_po_ok
    s_mov_b64 exec, s[94:95]
L_po_n0:
    buffer_load_dwordx4 v[144:147], v1, s[16:19], s58 offen offset:0 sc1
    buffer_load_dwordx4 v[148:151], v1, s[16:19], s58 offen offset:512 sc1
    buffer_load_dwordx4 v[152:155], v1, s[16:19], s58 offen offset:1024 sc1
    buffer_load_dwordx4 v[156:159], v1, s[16:19], s58 offen offset:1536 sc1
    s_sub_u32 s52, s52, 1
    s_cmp_lg_u32 s52, 0
    s_cbranch_scc1 L_po
L_po_ok:
    s_mov_b64 exec, -1
L_proj:
    s_waitcnt lgkmcnt(0)
    v_max_f32 v2, v38, v46
    s_nop 1
    v_max_f32_dpp v2, v2, v2 row_ror:8 row_mask:0xf bank_mask:0xf
    v_mov_b32 v3, v2
    s_nop 1
    v_permlane16_swap_b32 v3, v2
    v_max_f32 v2, v2, v3
    v_mov_b32 v3, v2
    s_nop 1
    v_permlane32_swap_b32 v3, v2
    v_max_f32 v2, v2, v3
    v_sub_f32 v4, v46, v2
    v_sub_f32 v2, v38, v2
    v_exp_f32 v4, v4
    v_exp_f32 v2, v2
    v_pk_mul_f32 v[40:41], v[40:41], v[4:5] op_sel_hi:[1,0]
    v_pk_mul_f32 v[42:43], v[42:43], v[4:5] op_sel_hi:[1,0]
    v_pk_mul_f32 v[44:45], v[44:45], v[4:5] op_sel_hi:[1,0]
    v_pk_mul_f32 v[46:47], v[46:47], v[4:5] op_sel_hi:[1,0]
    v_pk_fma_f32 v[32:33], v[32:33], v[2:3], v[40:41] op_sel_hi:[1,0,1]
    v_pk_fma_f32 v[34:35], v[34:35], v[2:3], v[42:43] op_sel_hi:[1,0,1]
    v_pk_fma_f32 v[36:37], v[36:37], v[2:3], v[44:45] op_sel_hi:[1,0,1]
    v_pk_fma_f32 v[38:39], v[38:39], v[2:3], v[46:47] op_sel_hi:[1,0,1]
    s_nop 0
    v_permlane32_swap_b32 v32, v36
    v_permlane32_swap_b32 v33, v37
    v_permlane32_swap_b32 v34, v38
    v_permlane32_swap_b32 v35, v39
    v_pk_add_f32 v[32:33], v[32:33], v[36:37]
    v_pk_add_f32 v[34:35], v[34:35], v[38:39]
    s_nop 1
    v_permlane16_swap_b32 v32, v34
    v_permlane16_swap_b32 v33, v35
    v_pk_add_f32 v[32:33], v[32:33], v[34:35]
    s_nop 1
    v_add_f32_dpp v33, v33, v33 row_ror:8 row_mask:0xf bank_mask:0xf
    v_add_f32_dpp v32, v32, v32 row_ror:8 row_mask:0xf bank_mask:0xf
    v_readlane_b32 s92, v33, 48
    s_nop 1
    v_rcp_f32 v2, s92
    s_nop 0
    v_pk_mul_f32 v[32:33], v[32:33], v[2:3] op_sel_hi:[1,0]
    v_cvt_pk_bf16_f32 v2, v32, v33
    s_nop 0
    v_readlane_b32 s92, v2, 0
    v_readlane_b32 s93, v2, 1
    v_readlane_b32 s96, v2, 2
    v_dot2_f32_bf16 v24, v96, s92, 0
    v_dot2_f32_bf16 v25, v97, s92, 0
    v_readlane_b32 s97, v2, 3
    v_dot2_f32_bf16 v26, v98, s93, 0
    v_dot2_f32_bf16 v27, v99, s93, 0
    v_readlane_b32 s98, v2, 4
    v_dot2_f32_bf16 v24, v100, s96, v24
    v_dot2_f32_bf16 v25, v101, s96, v25
    v_readlane_b32 s99, v2, 5
    v_dot2_f32_bf16 v26, v102, s97, v26
    v_dot2_f32_bf16 v27, v103, s97, v27
    v_readlane_b32 s100, v2, 6
    v_dot2_f32_bf16 v24, v104, s98, v24
    v_dot2_f32_bf16 v25, v105, s98, v25
    v_readlane_b32 s101, v2, 7
    v_dot2_f32_bf16 v26, v106, s99, v26
    v_dot2_f32_bf16 v27, v107, s99, v27
    v_readlane_b32 s92, v2, 16
    v_dot2_f32_bf16 v24, v108, s100, v24
    v_dot2_f32_bf16 v25, v109, s100, v25
    v_readlane_b32 s93, v2, 17
    v_dot2_f32_bf16 v26, v110, s101, v26
    v_dot2_f32_bf16 v27, v111, s101, v27
    v_readlane_b32 s96, v2, 18
    v_dot2_f32_bf16 v24, v112, s92, v24
    v_dot2_f32_bf16 v25, v113, s92, v25
    v_readlane_b32 s97, v2, 19
    v_dot2_f32_bf16 v26, v114, s93, v26
    v_dot2_f32_bf16 v27, v115, s93, v27
    v_readlane_b32 s98, v2, 20
    v_dot2_f32_bf16 v24, v116, s96, v24
    v_dot2_f32_bf16 v25, v117, s96, v25
    v_readlane_b32 s99, v2, 21
    v_dot2_f32_bf16 v26, v118, s97, v26
    v_dot2_f32_bf16 v27, v119, s97, v27
    v_readlane_b32 s100, v2, 22
    v_dot2_f32_bf16 v24, v120, s98, v24
    v_dot2_f32_bf16 v25, v121, s98, v25
    v_readlane_b32 s101, v2, 23
    v_dot2_f32_bf16 v26, v122, s99, v26
    v_dot2_f32_bf16 v27, v123, s99, v27
    v_readlane_b32 s92, v2, 32
    v_dot2_f32_bf16 v24, v124, s100, v24
    v_dot2_f32_bf16 v25, v125, s100, v25
    v_readlane_b32 s93, v2, 33
    v_dot2_f32_bf16 v26, v126, s101, v26
    v_dot2_f32_bf16 v27, v127, s101, v27
    v_readlane_b32 s96, v2, 34
    v_dot2_f32_bf16 v24, v128, s92, v24
    v_dot2_f32_bf16 v25, v129, s92, v25
    v_readlane_b32 s97, v2, 35
    v_dot2_f32_bf16 v26, v130, s93, v26
    v_dot2_f32_bf16 v27, v131, s93, v27
    v_readlane_b32 s98, v2, 36
    v_dot2_f32_bf16 v24, v132, s96, v24
    v_dot2_f32_bf16 v25, v133, s96, v25
    v_readlane_b32 s99, v2, 37
    v_dot2_f32_bf16 v26, v134, s97, v26
    v_dot2_f32_bf16 v27, v135, s97, v27
    v_readlane_b32 s100, v2, 38
    v_dot2_f32_bf16 v24, v136, s98, v24
    v_dot2_f32_bf16 v25, v137, s98, v25
    v_readlane_b32 s101, v2, 39
    v_dot2_f32_bf16 v26, v138, s99, v26
    v_dot2_f32_bf16 v27, v139, s99, v27
    v_dot2_f32_bf16 v24, v140, s100, v24
    v_dot2_f32_bf16 v25, v141, s100, v25
    v_dot2_f32_bf16 v26, v142, s101, v26
    v_dot2_f32_bf16 v27, v143, s101, v27
    s_nop 2
    v_pk_add_f32 v[24:25], v[24:25], v[26:27]
    ds_write_b64 v11, v[24:25] offset:8704
    s_cmp_lg_u32 s3, 0
    s_waitcnt lgkmcnt(0)
    s_barrier
    s_cbranch_scc1 L_fin
L_pub2:
    ds_read_b64 v[34:35], v10 offset:9216
    ds_read_b64 v[36:37], v10 offset:9728
    ds_read_b64 v[38:39], v10 offset:10240
    s_waitcnt lgkmcnt(1)
    v_pk_add_f32 v[24:25], v[24:25], v[34:35]
    s_waitcnt lgkmcnt(0)
    v_pk_add_f32 v[36:37], v[36:37], v[38:39]
    v_add_f32 v28, v24, v36
    v_add_f32 v30, v25, v37
    buffer_store_dwordx4 v[28:31], v7, s[16:19], s59 offen sc1
    s_branch L_fin
L_help_no:
    s_sub_u32 s6, s5, 5
    s_lshl_b32 s6, s6, 5
    s_add_u32 s30, s6, s4
    s_mov_b32 s24, s46
    s_mov_b32 s25, s47
    s_mov_b32 s26, 0x500
    s_mov_b32 s27, 0x20000
    v_lshlrev_b32 v1, 4, v240
    s_lshl_b32 s6, s30, 12
    s_add_u32 s6, s6, 1114112
    s_mov_b32 s52, 200000
    v_lshlrev_b32 v7, 2, v240
    s_lshl_b32 s59, s30, 5
    s_mov_b64 s[96:97], 0xff
    s_cmp_lg_u32 s3, 0
    s_cbranch_scc1 L_mb_out
    s_mov_b32 s53, 1312
    v_mul_u32_u24 v248, 3072, v240
    v_lshlrev_b32 v251, 2, v240
    s_mov_b32 s98, 0
L_mb_G:
    s_cmp_ge_u32 s98, 64
    s_cbranch_scc1 L_mb_last2
L_mb_w1:
    ds_read_b32 v244, v241 offset:388
    s_waitcnt lgkmcnt(0)
    v_readfirstlane_b32 s55, v244
    s_sub_u32 s55, s53, s55
    s_cmp_lt_i32 s55, 24
    s_cbranch_scc1 L_mb_w1_go
    s_sleep 2
    s_branch L_mb_w1
L_mb_w1_go:
L_mb_R:
    s_mov_b32 s55, 1
    s_atomic_add s55, s[50:51], s35 glc
    s_waitcnt lgkmcnt(0)
    s_mov_b32 s99, s98
    s_cmp_lt_u32 s55, 7
    s_cbranch_scc1 L_mb_T
    s_add_u32 s98, s98, 8
    s_add_u32 s35, s35, 8192
    s_cmp_eq_u32 s55, 7
    s_cbranch_scc1 L_mb_T
    s_cmp_lt_u32 s98, 64
    s_cbranch_scc1 L_mb_R
    s_branch L_mb_last2
L_mb_T:
    s_add_u32 s55, s55, s99
    s_lshr_b32 s93, s55, 3
    s_cmp_gt_u32 s93, 7
    s_cbranch_scc1 L_mb_last2
    s_lshr_b32 s92, 64, s93
    s_max_u32 s92, s92, 1
    s_and_b32 s55, s55, 7
    s_mul_i32 s55, s55, s92
    s_lshr_b32 s93, 1024, s93
    s_sub_u32 s55, s55, s93
    s_add_u32 s55, s55, 1024
    s_add_u32 s28, s55, s57
    v_add_u32 v249, s28, v240
    v_and_b32 v249, 4095, v249
    v_mul_u32_u24 v249, 3072, v249
    v_add_u32 v249, s56, v249
    v_add_u32 v244, s53, v251
    v_cmp_gt_u32 vcc, s92, v240
    s_mov_b64 exec, vcc
    ds_write_b32 v244, v249 offset:10752
    s_mov_b64 exec, -1
    s_lshl2_add_u32 s53, s92, s53
    s_branch L_mb_G
L_mb_last2:
    s_mov_b32 s55, 1024
L_mb_last:
    s_min_u32 s55, s55, 1024
    s_add_u32 s28, s55, s57
    v_add_u32 v249, s28, v240
    v_and_b32 v249, 4095, v249
    v_mul_u32_u24 v249, 3072, v249
    v_add_u32 v249, s56, v249
    s_sub_u32 s55, 1024, s55
    v_add_u32 v244, s53, v251
    v_mov_b32 v251, 0x7fffffff
    v_cmp_gt_u32 vcc, s55, v240
    s_nop 1
    v_cndmask_b32 v249, v251, v249, vcc
    ds_write_b32 v244, v249 offset:10752
    s_waitcnt vmcnt(0)
L_mb_out:
    s_waitcnt lgkmcnt(0)
    s_barrier
    s_cmp_lg_u32 s3, 0
    s_cbranch_scc1 L_fin
    s_cmp_ge_u32 s30, 40
    s_cbranch_scc1 L_fin
    s_mov_b64 s[94:95], -1
    buffer_load_dwordx4 v[144:147], v1, s[16:19], s6 offen offset:0 sc1
    buffer_load_dwordx4 v[148:151], v1, s[16:19], s6 offen offset:1024 sc1
    buffer_load_dwordx4 v[152:155], v1, s[16:19], s6 offen offset:2048 sc1
    buffer_load_dwordx4 v[156:159], v1, s[16:19], s6 offen offset:3072 sc1
    s_sleep 2
    buffer_load_dwordx4 v[160:163], v1, s[16:19], s6 offen offset:0 sc1
    buffer_load_dwordx4 v[164:167], v1, s[16:19], s6 offen offset:1024 sc1
    buffer_load_dwordx4 v[168:171], v1, s[16:19], s6 offen offset:2048 sc1
    buffer_load_dwordx4 v[172:175], v1, s[16:19], s6 offen offset:3072 sc1
    s_sleep 2
    buffer_load_dwordx4 v[176:179], v1, s[16:19], s6 offen offset:0 sc1
    buffer_load_dwordx4 v[180:183], v1, s[16:19], s6 offen offset:1024 sc1
    buffer_load_dwordx4 v[184:187], v1, s[16:19], s6 offen offset:2048 sc1
    buffer_load_dwordx4 v[188:191], v1, s[16:19], s6 offen offset:3072 sc1
    s_sleep 2
    buffer_load_dwordx4 v[192:195], v1, s[16:19], s6 offen offset:0 sc1
    buffer_load_dwordx4 v[196:199], v1, s[16:19], s6 offen offset:1024 sc1
    buffer_load_dwordx4 v[200:203], v1, s[16:19], s6 offen offset:2048 sc1
    buffer_load_dwordx4 v[204:207], v1, s[16:19], s6 offen offset:3072 sc1
L_py:
    s_waitcnt vmcnt(12)
    v_bitop3_b32 v2, v145, v147, s32 bitop3:0x7e
    v_bitop3_b32 v2, v2, v149, s32 bitop3:0xf6
    v_bitop3_b32 v2, v2, v151, s32 bitop3:0xf6
    v_bitop3_b32 v2, v2, v153, s32 bitop3:0xf6
    v_bitop3_b32 v2, v2, v155, s32 bitop3:0xf6
    v_bitop3_b32 v2, v2, v157, s32 bitop3:0xf6
    v_bitop3_b32 v2, v2, v159, s32 bitop3:0xf6
    v_cmp_eq_u32 vcc, 0, v2
    s_cbranch_vccz L_py_n0
    s_mov_b64 exec, vcc
    v_mov_b32 v32, v144
    v_mov_b32 v33, v146
    v_mov_b32 v34, v148
    v_mov_b32 v35, v150
    v_mov_b32 v36, v152
    v_mov_b32 v37, v154
    v_mov_b32 v38, v156
    v_mov_b32 v39, v158
    s_andn2_b64 s[94:95], s[94:95], vcc
    s_cbranch_scc0 L_py_ok
    s_mov_b64 exec, s[94:95]
L_py_n0:
    buffer_load_dwordx4 v[144:147], v1, s[16:19], s6 offen offset:0 sc1
    buffer_load_dwordx4 v[148:151], v1, s[16:19], s6 offen offset:1024 sc1
    buffer_load_dwordx4 v[152:155], v1, s[16:19], s6 offen offset:2048 sc1
    buffer_load_dwordx4 v[156:159], v1, s[16:19], s6 offen offset:3072 sc1
    s_sleep 1
    s_waitcnt vmcnt(12)
    v_bitop3_b32 v2, v161, v163, s32 bitop3:0x7e
    v_bitop3_b32 v2, v2, v165, s32 bitop3:0xf6
    v_bitop3_b32 v2, v2, v167, s32 bitop3:0xf6
    v_bitop3_b32 v2, v2, v169, s32 bitop3:0xf6
    v_bitop3_b32 v2, v2, v171, s32 bitop3:0xf6
    v_bitop3_b32 v2, v2, v173, s32 bitop3:0xf6
    v_bitop3_b32 v2, v2, v175, s32 bitop3:0xf6
    v_cmp_eq_u32 vcc, 0, v2
    s_cbranch_vccz L_py_n1
    s_mov_b64 exec, vcc
    v_mov_b32 v32, v160
    v_mov_b32 v33, v162
    v_mov_b32 v34, v164
    v_mov_b32 v35, v166
    v_mov_b32 v36, v168
    v_mov_b32 v37, v170
    v_mov_b32 v38, v172
    v_mov_b32 v39, v174
    s_andn2_b64 s[94:95], s[94:95], vcc
    s_cbranch_scc0 L_py_ok
    s_mov_b64 exec, s[94:95]
L_py_n1:
    buffer_load_dwordx4 v[160:163], v1, s[16:19], s6 offen offset:0 sc1
    buffer_load_dwordx4 v[164:167], v1, s[16:19], s6 offen offset:1024 sc1
    buffer_load_dwordx4 v[168:171], v1, s[16:19], s6 offen offset:2048 sc1
    buffer_load_dwordx4 v[172:175], v1, s[16:19], s6 offen offset:3072 sc1
    s_sleep 1
    s_waitcnt vmcnt(12)
    v_bitop3_b32 v2, v177, v179, s32 bitop3:0x7e
    v_bitop3_b32 v2, v2, v181, s32 bitop3:0xf6
    v_bitop3_b32 v2, v2, v183, s32 bitop3:0xf6
    v_bitop3_b32 v2, v2, v185, s32 bitop3:0xf6
    v_bitop3_b32 v2, v2, v187, s32 bitop3:0xf6
    v_bitop3_b32 v2, v2, v189, s32 bitop3:0xf6
    v_bitop3_b32 v2, v2, v191, s32 bitop3:0xf6
    v_cmp_eq_u32 vcc, 0, v2
    s_cbranch_vccz L_py_n2
    s_mov_b64 exec, vcc
    v_mov_b32 v32, v176
    v_mov_b32 v33, v178
    v_mov_b32 v34, v180
    v_mov_b32 v35, v182
    v_mov_b32 v36, v184
    v_mov_b32 v37, v186
    v_mov_b32 v38, v188
    v_mov_b32 v39, v190
    s_andn2_b64 s[94:95], s[94:95], vcc
    s_cbranch_scc0 L_py_ok
    s_mov_b64 exec, s[94:95]
L_py_n2:
    buffer_load_dwordx4 v[176:179], v1, s[16:19], s6 offen offset:0 sc1
    buffer_load_dwordx4 v[180:183], v1, s[16:19], s6 offen offset:1024 sc1
    buffer_load_dwordx4 v[184:187], v1, s[16:19], s6 offen offset:2048 sc1
    buffer_load_dwordx4 v[188:191], v1, s[16:19], s6 offen offset:3072 sc1
    s_sleep 1
    s_waitcnt vmcnt(12)
    v_bitop3_b32 v2, v193, v195, s32 bitop3:0x7e
    v_bitop3_b32 v2, v2, v197, s32 bitop3:0xf6
    v_bitop3_b32 v2, v2, v199, s32 bitop3:0xf6
    v_bitop3_b32 v2, v2, v201, s32 bitop3:0xf6
    v_bitop3_b32 v2, v2, v203, s32 bitop3:0xf6
    v_bitop3_b32 v2, v2, v205, s32 bitop3:0xf6
    v_bitop3_b32 v2, v2, v207, s32 bitop3:0xf6
    v_cmp_eq_u32 vcc, 0, v2
    s_cbranch_vccz L_py_n3
    s_mov_b64 exec, vcc
    v_mov_b32 v32, v192
    v_mov_b32 v33, v194
    v_mov_b32 v34, v196
    v_mov_b32 v35, v198
    v_mov_b32 v36, v200
    v_mov_b32 v37, v202
    v_mov_b32 v38, v204
    v_mov_b32 v39, v206
    s_andn2_b64 s[94:95], s[94:95], vcc
    s_cbranch_scc0 L_py_ok
    s_mov_b64 exec, s[94:95]
L_py_n3:
    buffer_load_dwordx4 v[192:195], v1, s[16:19], s6 offen offset:0 sc1
    buffer_load_dwordx4 v[196:199], v1, s[16:19], s6 offen offset:1024 sc1
    buffer_load_dwordx4 v[200:203], v1, s[16:19], s6 offen offset:2048 sc1
    buffer_load_dwordx4 v[204:207], v1, s[16:19], s6 offen offset:3072 sc1
    s_sleep 1
    s_sub_u32 s52, s52, 1
    s_cmp_lg_u32 s52, 0
    s_cbranch_scc1 L_py
L_py_ok:
    s_mov_b64 exec, -1
L_last:
    v_pk_add_f32 v[32:33], v[32:33], v[34:35]
    v_pk_add_f32 v[36:37], v[36:37], v[38:39]
    v_pk_add_f32 v[32:33], v[32:33], v[36:37]
    s_nop 1
    v_permlane32_swap_b32 v32, v33
    v_add_f32 v32, v32, v33
    s_nop 1
    v_add_f32_dpp v32, v32, v32 row_ror:8 row_mask:0xf bank_mask:0xf
    v_mov_b32 v33, v32
    s_nop 1
    v_permlane16_swap_b32 v33, v32
    v_add_f32 v32, v32, v33
    v_mov_b32 v33, v32
    s_nop 1
    v_permlane32_swap_b32 v32, v33
    v_cvt_pk_bf16_f32 v2, v32, v33
    s_and_b64 exec, exec, s[96:97]
    buffer_store_dword v2, v7, s[24:27], s59 offen
    s_cmp_lg_u32 s30, 0
    s_cbranch_scc1 L_noep
    s_mov_b64 exec, 1
    v_mov_b32 v5, s32
    buffer_store_dword v5, v241, s[16:19], 0 offen sc1
L_noep:
    s_mov_b64 exec, -1
L_fin:
    s_waitcnt vmcnt(0)
L_end:
    s_endpgm
.section .rodata,"a"
.p2align 6
.amdhsa_kernel standalone__gqa_block_cached__decode_kernel
  .amdhsa_next_free_vgpr 256
  .amdhsa_next_free_sgpr 102
  .amdhsa_accum_offset 256
  .amdhsa_group_segment_fixed_size 0
  .amdhsa_kernarg_size 64
  .amdhsa_user_sgpr_count 2
  .amdhsa_user_sgpr_kernarg_segment_ptr 1
  .amdhsa_system_sgpr_workgroup_id_x 1
.end_amdhsa_kernel
```
